```python
import torch

def _softmax(x, axis=-1):
    return torch.softmax(x, dim=axis)
def _gelu(x):
    return torch.nn.functional.gelu(x, approximate="tanh")
def _silu(x):
    return torch.nn.functional.silu(x)
def _sigmoid(x):
    return torch.sigmoid(x)
def _layernorm(x, axis=-1, eps=1e-5):
    m = x.mean(dim=axis, keepdim=True)
    v = x.var(dim=axis, keepdim=True, unbiased=False)
    return (x - m) / torch.sqrt(v + eps)
def _scatter_add(tgt, idx, src, axis=0):
    return tgt.clone().index_add_(axis, idx, src)
def _segment_sum(src, seg, n):
    out = torch.zeros((n,) + src.shape[1:], dtype=src.dtype)
    return out.index_add_(0, seg, src)
def _pad(x, pw):
    flat = tuple(v for pair in reversed(pw) for v in pair)
    return torch.nn.functional.pad(x, flat)

kernel_name = 'sequential_preLN__sliding_block_cached__swiglu_ffn__decode'

def setup_inputs():

    _w = (lambda a: (lambda t: t.to(torch.bfloat16) if t.is_floating_point() else t)(torch.as_tensor(a)))
    def _A_setup():
        B, Sq, D = 4, 1, 512
        Hq, Hkv, Sk, Dh = 32, 32, 8192, 128
        assert Hq % Hkv == 0, (Hq, Hkv)
        return {
            "x": _w((lambda *s: torch.randn(*s, dtype=torch.bfloat16) * 0.05)(B, Sq, D)),
            "k_cache": _w((lambda *s: torch.randn(*s, dtype=torch.bfloat16) * 3.2)(B, Hkv, Sk, Dh)),
            "v_cache": _w((lambda *s: torch.randn(*s, dtype=torch.bfloat16) * 0.4)(B, Hkv, Sk, Dh)),
            "wq": _w((lambda *s: torch.randn(*s, dtype=torch.bfloat16) * 3.2)(D, Hq * Dh) * (D ** -0.5)),
            "wo": _w((lambda *s: torch.randn(*s, dtype=torch.bfloat16) * 0.4)(Hq * Dh, D) * ((Hq * Dh) ** -0.5)),
        }
    _A_in = _A_setup()

    def _B_setup():
        B, S, D, F = 4, 1, 512, 1376
        return {
            "x": _w((lambda *s: torch.randn(*s, dtype=torch.bfloat16) * 0.05)(B, S, D)),
            "w_gate": _w((lambda *s: torch.randn(*s, dtype=torch.bfloat16) * 0.05)(D, F)),
            "w_up": _w((lambda *s: torch.randn(*s, dtype=torch.bfloat16) * 0.05)(D, F)),
            "w_down": _w((lambda *s: torch.randn(*s, dtype=torch.bfloat16) * 0.05)(F, D)),
        }
    _B_in = _B_setup()

    return {
        "A_x": _A_in["x"],
        "A_k_cache": _A_in["k_cache"],
        "A_v_cache": _A_in["v_cache"],
        "A_wq": _A_in["wq"],
        "A_wo": _A_in["wo"],
        "B_x": _B_in["x"],
        "B_w_gate": _B_in["w_gate"],
        "B_w_up": _B_in["w_up"],
        "B_w_down": _B_in["w_down"],
    }

def reference(A_x, A_k_cache, A_v_cache, A_wq, A_wo, B_x, B_w_gate, B_w_up, B_w_down):
    def _A_ref(x, k_cache, v_cache, wq, wo):
        B, Sq, D = x.shape
        Hq, Dh = 32, 128
        Hkv, Sk = k_cache.shape[1], k_cache.shape[2]
        W = min(4096, max(256, Sk // 4))
        rep = Hq // Hkv
        q = (lambda x, *d: x.permute(*d))((x @ wq).reshape(B, Sq, Hq, Dh), 0, 2, 1, 3)
        k = (lambda x, n, axis: torch.repeat_interleave(x, n, dim=axis))(k_cache[:, :, Sk - W:, :], rep, axis=1)
        v = (lambda x, n, axis: torch.repeat_interleave(x, n, dim=axis))(v_cache[:, :, Sk - W:, :], rep, axis=1)
        scores = torch.einsum("bhqd,bhkd->bhqk", q, k) * (Dh ** -0.5)
        p = _softmax(scores, axis=-1)
        o = torch.einsum("bhqk,bhkd->bhqd", p, v)
        return (lambda x, *d: x.permute(*d))(o, 0, 2, 1, 3).reshape(B, Sq, Hq * Dh) @ wo

    def _B_ref(x, w_gate, w_up, w_down):
        g = _silu(x @ w_gate)
        u = x @ w_up
        return (g * u) @ w_down

    x = A_x
    h = x + _A_ref(_layernorm(x, axis=-1), A_k_cache, A_v_cache, A_wq, A_wo)
    h2 = h + _B_ref(_layernorm(h, axis=-1), B_w_gate, B_w_up, B_w_down)
    return h2
```

```asm
; @launch grid=(256,1,1) block=(768,1,1) lds=70144
.amdgcn_target "amdgcn-amd-amdhsa--gfx950"
.text
.globl sequential_preLN__sliding_block_cached__swiglu_ffn__decode_kernel
.p2align 8
.type sequential_preLN__sliding_block_cached__swiglu_ffn__decode_kernel,@function
sequential_preLN__sliding_block_cached__swiglu_ffn__decode_kernel:
    s_cmp_ge_u32 s2, 256
    s_cbranch_scc1 L_END
    s_load_dwordx16 s[16:31], s[0:1], 0
    s_load_dwordx8 s[32:39], s[0:1], 64
    v_lshrrev_b32 v4, 6, v0
    v_and_b32 v1, 63, v0
    v_readfirstlane_b32 s3, v4
    v_lshrrev_b32 v2, 4, v1
    v_and_b32 v3, 15, v1
    s_and_b32 s4, s2, 7
    s_lshr_b32 s5, s2, 3
    s_and_b32 s6, s5, 3
    s_lshl_b32 s6, s6, 3
    s_add_u32 s6, s6, s4
    s_lshr_b32 s7, s2, 5
    s_lshr_b32 s8, s7, 1
    s_and_b32 s9, s7, 1
    s_mov_b32 s96, 0x3fb8aa3b
    s_mov_b32 s97, 0x3db504f3
    s_cmp_lt_u32 s3, 4
    s_cbranch_scc1 L_SERVICE
    s_sub_u32 s3, s3, 4
    s_lshl_b32 s10, s8, 5
    s_add_u32 s10, s10, s6
    s_lshl_b32 s10, s10, 21
    s_lshl_b32 s11, s9, 18
    s_add_u32 s10, s10, s11
    s_add_u32 s10, s10, 0x180000
    v_lshlrev_b32 v4, 4, v1
    s_mov_b32 s92, 0
    s_add_u32 s12, s3, s92
    s_and_b32 s12, s12, 31
    s_lshl_b32 s12, s12, 13
    s_add_u32 s13, s12, 4096
    s_waitcnt lgkmcnt(0)
    s_add_u32 s40, s18, s10
    s_addc_u32 s41, s19, 0
    s_and_b32 s41, s41, 0xffff
    s_mov_b32 s42, 0x40000
    s_mov_b32 s43, 0x20000
    s_add_u32 s44, s20, s10
    s_addc_u32 s45, s21, 0
    s_and_b32 s45, s45, 0xffff
    s_mov_b32 s46, 0x40000
    s_mov_b32 s47, 0x20000
    s_barrier
    buffer_load_dwordx4 v[40:43], v4, s[40:43], s12 offen offset:0 nt
    buffer_load_dwordx4 v[44:47], v4, s[40:43], s12 offen offset:1024 nt
    buffer_load_dwordx4 v[48:51], v4, s[40:43], s12 offen offset:2048 nt
    buffer_load_dwordx4 v[52:55], v4, s[40:43], s12 offen offset:3072 nt
    buffer_load_dwordx4 v[56:59], v4, s[40:43], s13 offen offset:0 nt
    buffer_load_dwordx4 v[60:63], v4, s[40:43], s13 offen offset:1024 nt
    buffer_load_dwordx4 v[64:67], v4, s[40:43], s13 offen offset:2048 nt
    buffer_load_dwordx4 v[68:71], v4, s[40:43], s13 offen offset:3072 nt
    v_lshlrev_b32 v5, 5, v3
    v_mov_b32 v38, 0xff7fffff
    v_mov_b32 v39, 0
    v_mov_b32 v6, 0
    v_mov_b32 v7, 1
    s_barrier
    buffer_load_dwordx4 v[72:75], v4, s[44:47], s12 offen offset:0 nt
    buffer_load_dwordx4 v[76:79], v4, s[44:47], s12 offen offset:1024 nt
    buffer_load_dwordx4 v[80:83], v4, s[44:47], s12 offen offset:2048 nt
    buffer_load_dwordx4 v[84:87], v4, s[44:47], s12 offen offset:3072 nt
    buffer_load_dwordx4 v[88:91], v4, s[44:47], s13 offen offset:0 nt
    buffer_load_dwordx4 v[92:95], v4, s[44:47], s13 offen offset:1024 nt
    buffer_load_dwordx4 v[96:99], v4, s[44:47], s13 offen offset:2048 nt
    buffer_load_dwordx4 v[100:103], v4, s[44:47], s13 offen offset:3072 nt
    ds_read_b128 v[22:25], v5 offset:14848
    ds_read_b128 v[26:29], v5 offset:14864
    ds_read_b128 v[14:17], v5 offset:15360
    ds_read_b128 v[18:21], v5 offset:15376
    ds_read_b128 v[30:33], v5 offset:15872
    ds_read_b128 v[34:37], v5 offset:15888
    s_waitcnt lgkmcnt(0)
    v_add_f32 v22, v22, v14
    v_add_f32 v23, v23, v15
    v_add_f32 v24, v24, v16
    v_add_f32 v25, v25, v17
    v_add_f32 v26, v26, v18
    v_add_f32 v27, v27, v19
    v_add_f32 v28, v28, v20
    v_add_f32 v29, v29, v21
    ds_read_b128 v[14:17], v5 offset:16384
    ds_read_b128 v[18:21], v5 offset:16400
    v_add_f32 v22, v22, v30
    v_add_f32 v23, v23, v31
    v_add_f32 v24, v24, v32
    v_add_f32 v25, v25, v33
    v_add_f32 v26, v26, v34
    v_add_f32 v27, v27, v35
    v_add_f32 v28, v28, v36
    v_add_f32 v29, v29, v37
    s_waitcnt lgkmcnt(0)
    v_add_f32 v22, v22, v14
    v_add_f32 v23, v23, v15
    v_add_f32 v24, v24, v16
    v_add_f32 v25, v25, v17
    v_add_f32 v26, v26, v18
    v_add_f32 v27, v27, v19
    v_add_f32 v28, v28, v20
    v_add_f32 v29, v29, v21
    v_cvt_pk_bf16_f32 v10, v22, v23
    v_cvt_pk_bf16_f32 v11, v24, v25
    v_cvt_pk_bf16_f32 v12, v26, v27
    v_cvt_pk_bf16_f32 v13, v28, v29
    v_mov_b32 v22, 0
    v_mov_b32 v23, 0
    v_mov_b32 v24, 0
    v_mov_b32 v25, 0
    v_mov_b32 v26, 0
    v_mov_b32 v27, 0
    v_mov_b32 v28, 0
    v_mov_b32 v29, 0
L_SLOOP:
    s_nop 2
    s_mov_b64 exec, 1
    ds_add_rtn_u32 v8, v6, v7 offset:320
    s_mov_b64 exec, -1
    s_waitcnt vmcnt(12)
    v_dot2_f32_bf16 v14, v40, v10, 0
    v_dot2_f32_bf16 v15, v44, v10, 0
    v_dot2_f32_bf16 v16, v48, v10, 0
    v_dot2_f32_bf16 v17, v52, v10, 0
    v_dot2c_f32_bf16 v14, v41, v11
    v_dot2c_f32_bf16 v15, v45, v11
    v_dot2c_f32_bf16 v16, v49, v11
    v_dot2c_f32_bf16 v17, v53, v11
    v_dot2c_f32_bf16 v14, v42, v12
    v_dot2c_f32_bf16 v15, v46, v12
    v_dot2c_f32_bf16 v16, v50, v12
    v_dot2c_f32_bf16 v17, v54, v12
    v_dot2c_f32_bf16 v14, v43, v13
    v_dot2c_f32_bf16 v15, v47, v13
    v_dot2c_f32_bf16 v16, v51, v13
    v_dot2c_f32_bf16 v17, v55, v13
    s_waitcnt lgkmcnt(0)
    v_readfirstlane_b32 s14, v8
    s_nop 3
    s_add_u32 s12, s14, s92
    s_and_b32 s12, s12, 31
    s_cmp_lt_u32 s14, 32
    s_cselect_b32 s12, s12, 64
    s_lshl_b32 s12, s12, 13
    s_add_u32 s13, s12, 4096
    buffer_load_dwordx4 v[40:43], v4, s[40:43], s12 offen offset:0 nt
    buffer_load_dwordx4 v[44:47], v4, s[40:43], s12 offen offset:1024 nt
    buffer_load_dwordx4 v[48:51], v4, s[40:43], s12 offen offset:2048 nt
    buffer_load_dwordx4 v[52:55], v4, s[40:43], s12 offen offset:3072 nt
    s_waitcnt vmcnt(12)
    v_dot2_f32_bf16 v18, v56, v10, 0
    v_dot2_f32_bf16 v19, v60, v10, 0
    v_dot2_f32_bf16 v20, v64, v10, 0
    v_dot2_f32_bf16 v21, v68, v10, 0
    v_dot2c_f32_bf16 v18, v57, v11
    v_dot2c_f32_bf16 v19, v61, v11
    v_dot2c_f32_bf16 v20, v65, v11
    v_dot2c_f32_bf16 v21, v69, v11
    v_dot2c_f32_bf16 v18, v58, v12
    v_dot2c_f32_bf16 v19, v62, v12
    v_dot2c_f32_bf16 v20, v66, v12
    v_dot2c_f32_bf16 v21, v70, v12
    v_dot2c_f32_bf16 v18, v59, v13
    v_dot2c_f32_bf16 v19, v63, v13
    v_dot2c_f32_bf16 v20, v67, v13
    v_dot2c_f32_bf16 v21, v71, v13
    buffer_load_dwordx4 v[56:59], v4, s[40:43], s13 offen offset:0 nt
    buffer_load_dwordx4 v[60:63], v4, s[40:43], s13 offen offset:1024 nt
    buffer_load_dwordx4 v[64:67], v4, s[40:43], s13 offen offset:2048 nt
    buffer_load_dwordx4 v[68:71], v4, s[40:43], s13 offen offset:3072 nt
    v_add_f32 v14, v14, v14 row_ror:8
    v_add_f32 v15, v15, v15 row_ror:8
    v_add_f32 v16, v16, v16 row_ror:8
    v_add_f32 v17, v17, v17 row_ror:8
    v_add_f32 v18, v18, v18 row_ror:8
    v_add_f32 v19, v19, v19 row_ror:8
    v_add_f32 v20, v20, v20 row_ror:8
    v_add_f32 v21, v21, v21 row_ror:8
    v_add_f32 v14, v14, v14 row_ror:4
    v_add_f32 v15, v15, v15 row_ror:4
    v_add_f32 v16, v16, v16 row_ror:4
    v_add_f32 v17, v17, v17 row_ror:4
    v_add_f32 v18, v18, v18 row_ror:4
    v_add_f32 v19, v19, v19 row_ror:4
    v_add_f32 v20, v20, v20 row_ror:4
    v_add_f32 v21, v21, v21 row_ror:4
    v_add_f32 v14, v14, v14 row_ror:2
    v_add_f32 v15, v15, v15 row_ror:2
    v_add_f32 v16, v16, v16 row_ror:2
    v_add_f32 v17, v17, v17 row_ror:2
    v_add_f32 v18, v18, v18 row_ror:2
    v_add_f32 v19, v19, v19 row_ror:2
    v_add_f32 v20, v20, v20 row_ror:2
    v_add_f32 v21, v21, v21 row_ror:2
    v_add_f32 v14, v14, v14 row_ror:1
    v_add_f32 v15, v15, v15 row_ror:1
    v_add_f32 v16, v16, v16 row_ror:1
    v_add_f32 v17, v17, v17 row_ror:1
    v_add_f32 v18, v18, v18 row_ror:1
    v_add_f32 v19, v19, v19 row_ror:1
    v_add_f32 v20, v20, v20 row_ror:1
    v_add_f32 v21, v21, v21 row_ror:1
    v_cvt_pk_bf16_f32 v30, v14, v15
    v_lshlrev_b32 v14, 16, v30
    v_and_b32 v15, 0xffff0000, v30
    v_cvt_pk_bf16_f32 v31, v16, v17
    v_lshlrev_b32 v16, 16, v31
    v_and_b32 v17, 0xffff0000, v31
    v_cvt_pk_bf16_f32 v32, v18, v19
    v_lshlrev_b32 v18, 16, v32
    v_and_b32 v19, 0xffff0000, v32
    v_cvt_pk_bf16_f32 v33, v20, v21
    v_lshlrev_b32 v20, 16, v33
    v_and_b32 v21, 0xffff0000, v33
    v_mul_f32 v14, s97, v14
    v_mul_f32 v15, s97, v15
    v_mul_f32 v16, s97, v16
    v_mul_f32 v17, s97, v17
    v_mul_f32 v18, s97, v18
    v_mul_f32 v19, s97, v19
    v_mul_f32 v20, s97, v20
    v_mul_f32 v21, s97, v21
    v_cvt_pk_bf16_f32 v30, v14, v15
    v_lshlrev_b32 v14, 16, v30
    v_and_b32 v15, 0xffff0000, v30
    v_cvt_pk_bf16_f32 v31, v16, v17
    v_lshlrev_b32 v16, 16, v31
    v_and_b32 v17, 0xffff0000, v31
    v_cvt_pk_bf16_f32 v32, v18, v19
    v_lshlrev_b32 v18, 16, v32
    v_and_b32 v19, 0xffff0000, v32
    v_cvt_pk_bf16_f32 v33, v20, v21
    v_lshlrev_b32 v20, 16, v33
    v_and_b32 v21, 0xffff0000, v33
    v_max3_f32 v30, v14, v15, v16
    v_max3_f32 v31, v17, v18, v19
    v_max3_f32 v32, v20, v21, v38
    v_max3_f32 v30, v30, v31, v32
    v_sub_f32 v9, v38, v30
    v_mov_b32 v38, v30
    v_sub_f32 v14, v14, v38
    v_sub_f32 v15, v15, v38
    v_sub_f32 v16, v16, v38
    v_sub_f32 v17, v17, v38
    v_sub_f32 v18, v18, v38
    v_sub_f32 v19, v19, v38
    v_sub_f32 v20, v20, v38
    v_sub_f32 v21, v21, v38
    v_mul_f32 v9, s96, v9
    v_mul_f32 v14, s96, v14
    v_mul_f32 v15, s96, v15
    v_mul_f32 v16, s96, v16
    v_mul_f32 v17, s96, v17
    v_mul_f32 v18, s96, v18
    v_mul_f32 v19, s96, v19
    v_mul_f32 v20, s96, v20
    v_mul_f32 v21, s96, v21
    v_exp_f32 v9, v9
    v_exp_f32 v14, v14
    v_exp_f32 v15, v15
    v_exp_f32 v16, v16
    v_exp_f32 v17, v17
    v_exp_f32 v18, v18
    v_exp_f32 v19, v19
    v_exp_f32 v20, v20
    v_exp_f32 v21, v21
    v_mul_f32 v39, v39, v9
    v_mul_f32 v22, v22, v9
    v_mul_f32 v23, v23, v9
    v_mul_f32 v24, v24, v9
    v_mul_f32 v25, v25, v9
    v_mul_f32 v26, v26, v9
    v_mul_f32 v27, v27, v9
    v_mul_f32 v28, v28, v9
    v_mul_f32 v29, v29, v9
    v_add_f32 v30, v14, v15
    v_add_f32 v31, v16, v17
    v_add_f32 v32, v18, v19
    v_add_f32 v33, v20, v21
    v_add_f32 v30, v30, v31
    v_add_f32 v32, v32, v33
    v_add_f32 v39, v39, v30
    v_add_f32 v39, v39, v32
    v_cvt_pk_bf16_f32 v14, v14, 0
    v_cvt_pk_bf16_f32 v15, v15, 0
    v_cvt_pk_bf16_f32 v16, v16, 0
    v_cvt_pk_bf16_f32 v17, v17, 0
    v_cvt_pk_bf16_f32 v18, v18, 0
    v_cvt_pk_bf16_f32 v19, v19, 0
    v_cvt_pk_bf16_f32 v20, v20, 0
    v_cvt_pk_bf16_f32 v21, v21, 0
    v_lshlrev_b32 v30, 16, v14
    v_lshlrev_b32 v31, 16, v15
    v_lshlrev_b32 v32, 16, v16
    v_lshlrev_b32 v33, 16, v17
    v_lshlrev_b32 v34, 16, v18
    v_lshlrev_b32 v35, 16, v19
    v_lshlrev_b32 v36, 16, v20
    v_lshlrev_b32 v37, 16, v21
    s_waitcnt vmcnt(14)
    v_dot2c_f32_bf16 v22, v72, v14
    v_dot2c_f32_bf16 v23, v72, v30
    v_dot2c_f32_bf16 v24, v73, v14
    v_dot2c_f32_bf16 v25, v73, v30
    v_dot2c_f32_bf16 v26, v74, v14
    v_dot2c_f32_bf16 v27, v74, v30
    v_dot2c_f32_bf16 v28, v75, v14
    v_dot2c_f32_bf16 v29, v75, v30
    v_dot2c_f32_bf16 v22, v76, v15
    v_dot2c_f32_bf16 v23, v76, v31
    v_dot2c_f32_bf16 v24, v77, v15
    v_dot2c_f32_bf16 v25, v77, v31
    v_dot2c_f32_bf16 v26, v78, v15
    v_dot2c_f32_bf16 v27, v78, v31
    v_dot2c_f32_bf16 v28, v79, v15
    v_dot2c_f32_bf16 v29, v79, v31
    buffer_load_dwordx4 v[72:75], v4, s[44:47], s12 offen offset:0 nt
    buffer_load_dwordx4 v[76:79], v4, s[44:47], s12 offen offset:1024 nt
    s_waitcnt vmcnt(14)
    v_dot2c_f32_bf16 v22, v80, v16
    v_dot2c_f32_bf16 v23, v80, v32
    v_dot2c_f32_bf16 v24, v81, v16
    v_dot2c_f32_bf16 v25, v81, v32
    v_dot2c_f32_bf16 v26, v82, v16
    v_dot2c_f32_bf16 v27, v82, v32
    v_dot2c_f32_bf16 v28, v83, v16
    v_dot2c_f32_bf16 v29, v83, v32
    v_dot2c_f32_bf16 v22, v84, v17
    v_dot2c_f32_bf16 v23, v84, v33
    v_dot2c_f32_bf16 v24, v85, v17
    v_dot2c_f32_bf16 v25, v85, v33
    v_dot2c_f32_bf16 v26, v86, v17
    v_dot2c_f32_bf16 v27, v86, v33
    v_dot2c_f32_bf16 v28, v87, v17
    v_dot2c_f32_bf16 v29, v87, v33
    buffer_load_dwordx4 v[80:83], v4, s[44:47], s12 offen offset:2048 nt
    buffer_load_dwordx4 v[84:87], v4, s[44:47], s12 offen offset:3072 nt
    s_waitcnt vmcnt(14)
    v_dot2c_f32_bf16 v22, v88, v18
    v_dot2c_f32_bf16 v23, v88, v34
    v_dot2c_f32_bf16 v24, v89, v18
    v_dot2c_f32_bf16 v25, v89, v34
    v_dot2c_f32_bf16 v26, v90, v18
    v_dot2c_f32_bf16 v27, v90, v34
    v_dot2c_f32_bf16 v28, v91, v18
    v_dot2c_f32_bf16 v29, v91, v34
    v_dot2c_f32_bf16 v22, v92, v19
    v_dot2c_f32_bf16 v23, v92, v35
    v_dot2c_f32_bf16 v24, v93, v19
    v_dot2c_f32_bf16 v25, v93, v35
    v_dot2c_f32_bf16 v26, v94, v19
    v_dot2c_f32_bf16 v27, v94, v35
    v_dot2c_f32_bf16 v28, v95, v19
    v_dot2c_f32_bf16 v29, v95, v35
    buffer_load_dwordx4 v[88:91], v4, s[44:47], s13 offen offset:0 nt
    buffer_load_dwordx4 v[92:95], v4, s[44:47], s13 offen offset:1024 nt
    s_waitcnt vmcnt(14)
    v_dot2c_f32_bf16 v22, v96, v20
    v_dot2c_f32_bf16 v23, v96, v36
    v_dot2c_f32_bf16 v24, v97, v20
    v_dot2c_f32_bf16 v25, v97, v36
    v_dot2c_f32_bf16 v26, v98, v20
    v_dot2c_f32_bf16 v27, v98, v36
    v_dot2c_f32_bf16 v28, v99, v20
    v_dot2c_f32_bf16 v29, v99, v36
    v_dot2c_f32_bf16 v22, v100, v21
    v_dot2c_f32_bf16 v23, v100, v37
    v_dot2c_f32_bf16 v24, v101, v21
    v_dot2c_f32_bf16 v25, v101, v37
    v_dot2c_f32_bf16 v26, v102, v21
    v_dot2c_f32_bf16 v27, v102, v37
    v_dot2c_f32_bf16 v28, v103, v21
    v_dot2c_f32_bf16 v29, v103, v37
    buffer_load_dwordx4 v[96:99], v4, s[44:47], s13 offen offset:2048 nt
    buffer_load_dwordx4 v[100:103], v4, s[44:47], s13 offen offset:3072 nt
    s_cmp_lt_u32 s14, 32
    s_cbranch_scc1 L_SLOOP
L_SDONE:
    v_mov_b32 v30, v38
    v_mov_b32 v32, v30
    s_nop 1
    v_permlane16_swap_b32 v30, v32
    v_max_f32 v30, v30, v32
    v_mov_b32 v32, v30
    s_nop 1
    v_permlane32_swap_b32 v30, v32
    v_max_f32 v30, v30, v32
    v_sub_f32 v9, v38, v30
    v_mul_f32 v9, s96, v9
    v_exp_f32 v9, v9
    s_nop 0
    v_mul_f32 v31, v39, v9
    v_mul_f32 v22, v22, v9
    v_mul_f32 v23, v23, v9
    v_mul_f32 v24, v24, v9
    v_mul_f32 v25, v25, v9
    v_mul_f32 v26, v26, v9
    v_mul_f32 v27, v27, v9
    v_mul_f32 v28, v28, v9
    v_mul_f32 v29, v29, v9
    v_mov_b32 v32, v31
    s_nop 1
    v_permlane16_swap_b32 v31, v32
    v_add_f32 v31, v31, v32
    v_mov_b32 v32, v31
    s_nop 1
    v_permlane32_swap_b32 v31, v32
    v_add_f32 v31, v31, v32
    v_permlane32_swap_b32 v22, v26
    v_permlane32_swap_b32 v23, v27
    v_permlane32_swap_b32 v24, v28
    v_permlane32_swap_b32 v25, v29
    v_add_f32 v22, v22, v26
    v_add_f32 v23, v23, v27
    v_add_f32 v24, v24, v28
    v_add_f32 v25, v25, v29
    s_nop 0
    v_permlane16_swap_b32 v22, v24
    v_permlane16_swap_b32 v23, v25
    v_add_f32 v22, v22, v24
    v_add_f32 v23, v23, v25
    s_lshl_b32 s11, s3, 3
    v_mov_b32 v6, s11
    ds_write_b64 v6, v[30:31] offset:256
    s_lshl_b32 s11, s3, 9
    v_lshlrev_b32 v5, 5, v3
    v_lshl_add_u32 v6, v2, 3, v5
    v_add_u32 v6, s11, v6
    ds_write_b64 v6, v[22:23] offset:512
    s_waitcnt lgkmcnt(0)
    s_barrier
    s_endpgm
L_SERVICE:
    s_lshl_b32 s93, s8, 6
    s_lshl_b32 s10, s6, 1
    s_add_u32 s93, s93, s10
    s_add_u32 s93, s93, s9
    s_lshl_b32 s93, s93, 12
    s_mov_b32 s94, 0
    s_mul_i32 s95, s4, 11
    s_add_u32 s95, s95, s5
    s_cmp_lt_u32 s5, 11
    s_cselect_b32 s10, 1, 0
    s_cmp_lt_u32 s95, 86
    s_cselect_b32 s11, 1, 0
    s_and_b32 s94, s10, s11
    s_sub_u32 s10, s5, 11
    s_cmp_lt_u32 s10, 4
    s_cbranch_scc0 L_role_1
    s_mov_b32 s94, 2
    s_lshl_b32 s95, s4, 2
    s_add_u32 s95, s95, s10
L_role_1:
    s_sub_u32 s10, s5, 16
    s_cmp_lt_u32 s10, 8
    s_cbranch_scc0 L_role_2
    s_mov_b32 s94, 3
    s_lshl_b32 s95, s10, 3
    s_add_u32 s95, s95, s4
L_role_2:
    s_lshl_b32 s12, s95, 6
    s_and_b32 s12, s12, 0xfff
    s_add_u32 s13, s12, 1048576
    s_lshl_b32 s10, s8, 10
    v_lshl_add_u32 v5, v1, 4, s10
    s_lshl_b32 s10, s3, 20
    s_lshl_b32 s11, s6, 8
    s_add_u32 s10, s10, s11
    v_lshlrev_b32 v4, 18, v2
    v_lshl_add_u32 v4, v3, 4, v4
    v_add_u32 v4, s10, v4
    s_waitcnt lgkmcnt(0)
    s_mov_b32 s48, s38
    s_and_b32 s49, s39, 0xffff
    s_mov_b32 s50, 1097728
    s_mov_b32 s51, 0x20000
    s_mov_b32 s40, s22
    s_and_b32 s41, s23, 0xffff
    s_mov_b32 s42, 4194304
    s_mov_b32 s43, 0x20000
    s_mov_b32 s44, s24
    s_and_b32 s45, s25, 0xffff
    s_mov_b32 s46, 4194304
    s_mov_b32 s47, 0x20000
    s_cmp_eq_u32 s3, 3
    s_cbranch_scc0 L_noclr_3
    v_mov_b32 v160, -1
    v_mov_b32 v161, -1
    v_mov_b32 v162, -1
    v_mov_b32 v163, -1
    v_lshl_add_u32 v11, v1, 4, s93
    buffer_store_dwordx4 v[160:163], v11, s[48:51], 0 offen sc1
    buffer_store_dwordx4 v[160:163], v11, s[48:51], 0 offen offset:1024 sc1
    v_mov_b32 v16, 2147418112
    s_add_u32 s10, s93, 2048
    v_mov_b32 v17, s10
    v_cmp_eq_u32 vcc, 0, v1
    s_nop 1
    v_cndmask_b32 v16, v16, v17, vcc
    v_and_b32 v18, 7, v1
    v_lshrrev_b32 v19, 1, v18
    v_and_b32 v18, 1, v18
    v_lshrrev_b32 v20, 3, v1
    s_lshl_b32 s10, s95, 5
    s_add_u32 s10, s10, 1052672
    s_cmp_eq_u32 s94, 1
    s_cselect_b32 s10, s10, 2147418112
    v_mul_u32_u24 v17, 2752, v19
    v_lshl_add_u32 v17, v18, 4, v17
    v_add_u32 v17, s10, v17
    v_cmp_eq_u32 vcc, 2, v20
    s_nop 1
    v_cndmask_b32 v16, v16, v17, vcc
    s_cmp_eq_u32 s94, 3
    s_cselect_b32 s10, s13, 2147418112
    v_subrev_u32 v17, 24, v1
    v_cmp_gt_u32 vcc, 4, v17
    v_lshl_add_u32 v17, v17, 4, s10
    s_nop 0
    v_cndmask_b32 v16, v16, v17, vcc
    buffer_store_dwordx4 v[160:163], v16, s[48:51], 0 offen sc1
L_noclr_3:
    s_nop 1
    global_load_dwordx4 v[12:15], v5, s[16:17]
    s_mov_b32 s10, 0
    buffer_load_dwordx4 v[32:35], v4, s[40:43], s10 offen nt
    s_mov_b32 s10, 8192
    buffer_load_dwordx4 v[36:39], v4, s[40:43], s10 offen nt
    s_mov_b32 s10, 16384
    buffer_load_dwordx4 v[40:43], v4, s[40:43], s10 offen nt
    s_mov_b32 s10, 24576
    buffer_load_dwordx4 v[44:47], v4, s[40:43], s10 offen nt
    s_mov_b32 s10, 32768
    buffer_load_dwordx4 v[48:51], v4, s[40:43], s10 offen nt
    s_mov_b32 s10, 40960
    buffer_load_dwordx4 v[52:55], v4, s[40:43], s10 offen nt
    s_mov_b32 s10, 49152
    buffer_load_dwordx4 v[56:59], v4, s[40:43], s10 offen nt
    s_mov_b32 s10, 57344
    buffer_load_dwordx4 v[60:63], v4, s[40:43], s10 offen nt
    s_mov_b32 s10, 65536
    buffer_load_dwordx4 v[64:67], v4, s[40:43], s10 offen nt
    s_mov_b32 s10, 73728
    buffer_load_dwordx4 v[68:71], v4, s[40:43], s10 offen nt
    s_mov_b32 s10, 81920
    buffer_load_dwordx4 v[72:75], v4, s[40:43], s10 offen nt
    s_mov_b32 s10, 90112
    buffer_load_dwordx4 v[76:79], v4, s[40:43], s10 offen nt
    s_mov_b32 s10, 98304
    buffer_load_dwordx4 v[80:83], v4, s[40:43], s10 offen nt
    s_mov_b32 s10, 106496
    buffer_load_dwordx4 v[84:87], v4, s[40:43], s10 offen nt
    s_mov_b32 s10, 114688
    buffer_load_dwordx4 v[88:91], v4, s[40:43], s10 offen nt
    s_mov_b32 s10, 122880
    buffer_load_dwordx4 v[92:95], v4, s[40:43], s10 offen nt
    s_mov_b32 s10, 131072
    buffer_load_dwordx4 v[96:99], v4, s[40:43], s10 offen nt
    s_mov_b32 s10, 139264
    buffer_load_dwordx4 v[100:103], v4, s[40:43], s10 offen nt
    s_mov_b32 s10, 147456
    buffer_load_dwordx4 v[104:107], v4, s[40:43], s10 offen nt
    s_mov_b32 s10, 155648
    buffer_load_dwordx4 v[108:111], v4, s[40:43], s10 offen nt
    s_mov_b32 s10, 163840
    buffer_load_dwordx4 v[112:115], v4, s[40:43], s10 offen nt
    s_mov_b32 s10, 172032
    buffer_load_dwordx4 v[116:119], v4, s[40:43], s10 offen nt
    s_mov_b32 s10, 180224
    buffer_load_dwordx4 v[120:123], v4, s[40:43], s10 offen nt
    s_mov_b32 s10, 188416
    buffer_load_dwordx4 v[124:127], v4, s[40:43], s10 offen nt
    s_mov_b32 s10, 196608
    buffer_load_dwordx4 v[128:131], v4, s[40:43], s10 offen nt
    s_mov_b32 s10, 204800
    buffer_load_dwordx4 v[132:135], v4, s[40:43], s10 offen nt
    s_mov_b32 s10, 212992
    buffer_load_dwordx4 v[136:139], v4, s[40:43], s10 offen nt
    s_mov_b32 s10, 221184
    buffer_load_dwordx4 v[140:143], v4, s[40:43], s10 offen nt
    s_mov_b32 s10, 229376
    buffer_load_dwordx4 v[144:147], v4, s[40:43], s10 offen nt
    s_mov_b32 s10, 237568
    buffer_load_dwordx4 v[148:151], v4, s[40:43], s10 offen nt
    s_mov_b32 s10, 245760
    buffer_load_dwordx4 v[152:155], v4, s[40:43], s10 offen nt
    s_mov_b32 s10, 253952
    buffer_load_dwordx4 v[156:159], v4, s[40:43], s10 offen nt
    s_barrier
    s_waitcnt vmcnt(32)
    v_lshlrev_b32 v16, 16, v12
    v_and_b32 v17, 0xffff0000, v12
    v_lshlrev_b32 v18, 16, v13
    v_and_b32 v19, 0xffff0000, v13
    v_lshlrev_b32 v20, 16, v14
    v_and_b32 v21, 0xffff0000, v14
    v_lshlrev_b32 v22, 16, v15
    v_and_b32 v23, 0xffff0000, v15
    v_add_f32 v24, v16, v17
    v_add_f32 v25, v18, v19
    v_add_f32 v26, v20, v21
    v_add_f32 v27, v22, v23
    v_add_f32 v24, v24, v25
    v_add_f32 v26, v26, v27
    v_add_f32 v24, v24, v26
    s_nop 1
    v_add_f32 v24, v24, v24 row_ror:8
    s_nop 1
    v_add_f32 v24, v24, v24 row_ror:4
    s_nop 1
    v_add_f32 v24, v24, v24 row_ror:2
    s_nop 1
    v_add_f32 v24, v24, v24 row_ror:1
    v_mov_b32 v7, v24
    s_nop 1
    v_permlane16_swap_b32 v24, v7
    v_add_f32 v24, v24, v7
    v_mov_b32 v7, v24
    s_nop 1
    v_permlane32_swap_b32 v24, v7
    v_add_f32 v24, v24, v7
    v_mul_f32 v24, 0x3b000000, v24
    v_mov_b32 v26, v24
    v_cvt_pk_bf16_f32 v25, v26, v26
    v_lshlrev_b32 v26, 16, v25
    v_sub_f32 v8, v16, v24
    v_sub_f32 v9, v17, v24
    v_sub_f32 v10, v18, v24
    v_sub_f32 v11, v19, v24
    v_sub_f32 v12, v20, v24
    v_sub_f32 v13, v21, v24
    v_sub_f32 v14, v22, v24
    v_sub_f32 v15, v23, v24
    v_mul_f32 v27, v8, v8
    v_fmac_f32 v27, v9, v9
    v_fmac_f32 v27, v10, v10
    v_fmac_f32 v27, v11, v11
    v_fmac_f32 v27, v12, v12
    v_fmac_f32 v27, v13, v13
    v_fmac_f32 v27, v14, v14
    v_fmac_f32 v27, v15, v15
    s_nop 1
    v_add_f32 v27, v27, v27 row_ror:8
    s_nop 1
    v_add_f32 v27, v27, v27 row_ror:4
    s_nop 1
    v_add_f32 v27, v27, v27 row_ror:2
    s_nop 1
    v_add_f32 v27, v27, v27 row_ror:1
    v_mov_b32 v7, v27
    s_nop 1
    v_permlane16_swap_b32 v27, v7
    v_add_f32 v27, v27, v7
    v_mov_b32 v7, v27
    s_nop 1
    v_permlane32_swap_b32 v27, v7
    v_add_f32 v27, v27, v7
    v_mul_f32 v27, 0x3b000000, v27
    v_cvt_pk_bf16_f32 v25, v27, v27
    v_lshlrev_b32 v27, 16, v25
    v_add_f32 v27, 0x3727c5ac, v27
    v_cvt_pk_bf16_f32 v25, v27, v27
    v_lshlrev_b32 v27, 16, v25
    v_sqrt_f32 v27, v27
    s_nop 0
    v_cvt_pk_bf16_f32 v25, v27, v27
    v_lshlrev_b32 v27, 16, v25
    v_rcp_f32 v28, v27
    v_sub_f32 v16, v16, v26
    v_sub_f32 v17, v17, v26
    v_sub_f32 v18, v18, v26
    v_sub_f32 v19, v19, v26
    v_sub_f32 v20, v20, v26
    v_sub_f32 v21, v21, v26
    v_sub_f32 v22, v22, v26
    v_sub_f32 v23, v23, v26
    v_cvt_pk_bf16_f32 v24, v16, v17
    v_lshlrev_b32 v16, 16, v24
    v_and_b32 v17, 0xffff0000, v24
    v_cvt_pk_bf16_f32 v24, v18, v19
    v_lshlrev_b32 v18, 16, v24
    v_and_b32 v19, 0xffff0000, v24
    v_cvt_pk_bf16_f32 v24, v20, v21
    v_lshlrev_b32 v20, 16, v24
    v_and_b32 v21, 0xffff0000, v24
    v_cvt_pk_bf16_f32 v24, v22, v23
    v_lshlrev_b32 v22, 16, v24
    v_and_b32 v23, 0xffff0000, v24
    v_mul_f32 v8, v16, v28
    v_mul_f32 v9, v17, v28
    v_mul_f32 v10, v18, v28
    v_mul_f32 v11, v19, v28
    v_mul_f32 v12, v20, v28
    v_mul_f32 v13, v21, v28
    v_mul_f32 v14, v22, v28
    v_mul_f32 v15, v23, v28
    v_fma_f32 v16, -v8, v27, v16
    v_fma_f32 v17, -v9, v27, v17
    v_fma_f32 v18, -v10, v27, v18
    v_fma_f32 v19, -v11, v27, v19
    v_fma_f32 v20, -v12, v27, v20
    v_fma_f32 v21, -v13, v27, v21
    v_fma_f32 v22, -v14, v27, v22
    v_fma_f32 v23, -v15, v27, v23
    v_fma_f32 v16, v16, v28, v8
    v_fma_f32 v17, v17, v28, v9
    v_fma_f32 v18, v18, v28, v10
    v_fma_f32 v19, v19, v28, v11
    v_fma_f32 v20, v20, v28, v12
    v_fma_f32 v21, v21, v28, v13
    v_fma_f32 v22, v22, v28, v14
    v_fma_f32 v23, v23, v28, v15
    v_cvt_pk_bf16_f32 v24, v16, v17
    v_lshlrev_b32 v16, 16, v24
    v_and_b32 v17, 0xffff0000, v24
    v_cvt_pk_bf16_f32 v24, v18, v19
    v_lshlrev_b32 v18, 16, v24
    v_and_b32 v19, 0xffff0000, v24
    v_cvt_pk_bf16_f32 v24, v20, v21
    v_lshlrev_b32 v20, 16, v24
    v_and_b32 v21, 0xffff0000, v24
    v_cvt_pk_bf16_f32 v24, v22, v23
    v_lshlrev_b32 v22, 16, v24
    v_and_b32 v23, 0xffff0000, v24
    v_lshlrev_b32 v5, 5, v1
    ds_write_b128 v5, v[16:19] offset:12800
    ds_write_b128 v5, v[20:23] offset:12816
    s_lshl_b32 s10, s3, 9
    v_lshl_add_u32 v5, v2, 7, s10
    s_waitcnt lgkmcnt(0)
    v_mov_b32 v8, 0
    v_mov_b32 v9, 0
    v_mov_b32 v10, 0
    v_mov_b32 v11, 0
    v_mov_b32 v12, 0
    v_mov_b32 v13, 0
    v_mov_b32 v14, 0
    v_mov_b32 v15, 0
    ds_read_b128 v[16:19], v5 offset:12800
    s_waitcnt vmcnt(28)
    s_waitcnt lgkmcnt(0)
    v_lshrrev_b32 v20, 16, v16
    v_lshrrev_b32 v21, 16, v17
    v_lshrrev_b32 v22, 16, v18
    v_lshrrev_b32 v23, 16, v19
    v_dot2c_f32_bf16 v8, v32, v20
    v_dot2c_f32_bf16 v9, v32, v16
    v_dot2c_f32_bf16 v10, v33, v20
    v_dot2c_f32_bf16 v11, v33, v16
    v_dot2c_f32_bf16 v12, v34, v20
    v_dot2c_f32_bf16 v13, v34, v16
    v_dot2c_f32_bf16 v14, v35, v20
    v_dot2c_f32_bf16 v15, v35, v16
    v_dot2c_f32_bf16 v8, v36, v21
    v_dot2c_f32_bf16 v9, v36, v17
    v_dot2c_f32_bf16 v10, v37, v21
    v_dot2c_f32_bf16 v11, v37, v17
    v_dot2c_f32_bf16 v12, v38, v21
    v_dot2c_f32_bf16 v13, v38, v17
    v_dot2c_f32_bf16 v14, v39, v21
    v_dot2c_f32_bf16 v15, v39, v17
    v_dot2c_f32_bf16 v8, v40, v22
    v_dot2c_f32_bf16 v9, v40, v18
    v_dot2c_f32_bf16 v10, v41, v22
    v_dot2c_f32_bf16 v11, v41, v18
    v_dot2c_f32_bf16 v12, v42, v22
    v_dot2c_f32_bf16 v13, v42, v18
    v_dot2c_f32_bf16 v14, v43, v22
    v_dot2c_f32_bf16 v15, v43, v18
    v_dot2c_f32_bf16 v8, v44, v23
    v_dot2c_f32_bf16 v9, v44, v19
    v_dot2c_f32_bf16 v10, v45, v23
    v_dot2c_f32_bf16 v11, v45, v19
    v_dot2c_f32_bf16 v12, v46, v23
    v_dot2c_f32_bf16 v13, v46, v19
    v_dot2c_f32_bf16 v14, v47, v23
    v_dot2c_f32_bf16 v15, v47, v19
    ds_read_b128 v[16:19], v5 offset:12816
    s_waitcnt vmcnt(24)
    s_waitcnt lgkmcnt(0)
    v_lshrrev_b32 v20, 16, v16
    v_lshrrev_b32 v21, 16, v17
    v_lshrrev_b32 v22, 16, v18
    v_lshrrev_b32 v23, 16, v19
    v_dot2c_f32_bf16 v8, v48, v20
    v_dot2c_f32_bf16 v9, v48, v16
    v_dot2c_f32_bf16 v10, v49, v20
    v_dot2c_f32_bf16 v11, v49, v16
    v_dot2c_f32_bf16 v12, v50, v20
    v_dot2c_f32_bf16 v13, v50, v16
    v_dot2c_f32_bf16 v14, v51, v20
    v_dot2c_f32_bf16 v15, v51, v16
    v_dot2c_f32_bf16 v8, v52, v21
    v_dot2c_f32_bf16 v9, v52, v17
    v_dot2c_f32_bf16 v10, v53, v21
    v_dot2c_f32_bf16 v11, v53, v17
    v_dot2c_f32_bf16 v12, v54, v21
    v_dot2c_f32_bf16 v13, v54, v17
    v_dot2c_f32_bf16 v14, v55, v21
    v_dot2c_f32_bf16 v15, v55, v17
    v_dot2c_f32_bf16 v8, v56, v22
    v_dot2c_f32_bf16 v9, v56, v18
    v_dot2c_f32_bf16 v10, v57, v22
    v_dot2c_f32_bf16 v11, v57, v18
    v_dot2c_f32_bf16 v12, v58, v22
    v_dot2c_f32_bf16 v13, v58, v18
    v_dot2c_f32_bf16 v14, v59, v22
    v_dot2c_f32_bf16 v15, v59, v18
    v_dot2c_f32_bf16 v8, v60, v23
    v_dot2c_f32_bf16 v9, v60, v19
    v_dot2c_f32_bf16 v10, v61, v23
    v_dot2c_f32_bf16 v11, v61, v19
    v_dot2c_f32_bf16 v12, v62, v23
    v_dot2c_f32_bf16 v13, v62, v19
    v_dot2c_f32_bf16 v14, v63, v23
    v_dot2c_f32_bf16 v15, v63, v19
    ds_read_b128 v[16:19], v5 offset:12832
    s_waitcnt vmcnt(20)
    s_waitcnt lgkmcnt(0)
    v_lshrrev_b32 v20, 16, v16
    v_lshrrev_b32 v21, 16, v17
    v_lshrrev_b32 v22, 16, v18
    v_lshrrev_b32 v23, 16, v19
    v_dot2c_f32_bf16 v8, v64, v20
    v_dot2c_f32_bf16 v9, v64, v16
    v_dot2c_f32_bf16 v10, v65, v20
    v_dot2c_f32_bf16 v11, v65, v16
    v_dot2c_f32_bf16 v12, v66, v20
    v_dot2c_f32_bf16 v13, v66, v16
    v_dot2c_f32_bf16 v14, v67, v20
    v_dot2c_f32_bf16 v15, v67, v16
    v_dot2c_f32_bf16 v8, v68, v21
    v_dot2c_f32_bf16 v9, v68, v17
    v_dot2c_f32_bf16 v10, v69, v21
    v_dot2c_f32_bf16 v11, v69, v17
    v_dot2c_f32_bf16 v12, v70, v21
    v_dot2c_f32_bf16 v13, v70, v17
    v_dot2c_f32_bf16 v14, v71, v21
    v_dot2c_f32_bf16 v15, v71, v17
    v_dot2c_f32_bf16 v8, v72, v22
    v_dot2c_f32_bf16 v9, v72, v18
    v_dot2c_f32_bf16 v10, v73, v22
    v_dot2c_f32_bf16 v11, v73, v18
    v_dot2c_f32_bf16 v12, v74, v22
    v_dot2c_f32_bf16 v13, v74, v18
    v_dot2c_f32_bf16 v14, v75, v22
    v_dot2c_f32_bf16 v15, v75, v18
    v_dot2c_f32_bf16 v8, v76, v23
    v_dot2c_f32_bf16 v9, v76, v19
    v_dot2c_f32_bf16 v10, v77, v23
    v_dot2c_f32_bf16 v11, v77, v19
    v_dot2c_f32_bf16 v12, v78, v23
    v_dot2c_f32_bf16 v13, v78, v19
    v_dot2c_f32_bf16 v14, v79, v23
    v_dot2c_f32_bf16 v15, v79, v19
    ds_read_b128 v[16:19], v5 offset:12848
    s_waitcnt vmcnt(16)
    s_waitcnt lgkmcnt(0)
    v_lshrrev_b32 v20, 16, v16
    v_lshrrev_b32 v21, 16, v17
    v_lshrrev_b32 v22, 16, v18
    v_lshrrev_b32 v23, 16, v19
    v_dot2c_f32_bf16 v8, v80, v20
    v_dot2c_f32_bf16 v9, v80, v16
    v_dot2c_f32_bf16 v10, v81, v20
    v_dot2c_f32_bf16 v11, v81, v16
    v_dot2c_f32_bf16 v12, v82, v20
    v_dot2c_f32_bf16 v13, v82, v16
    v_dot2c_f32_bf16 v14, v83, v20
    v_dot2c_f32_bf16 v15, v83, v16
    v_dot2c_f32_bf16 v8, v84, v21
    v_dot2c_f32_bf16 v9, v84, v17
    v_dot2c_f32_bf16 v10, v85, v21
    v_dot2c_f32_bf16 v11, v85, v17
    v_dot2c_f32_bf16 v12, v86, v21
    v_dot2c_f32_bf16 v13, v86, v17
    v_dot2c_f32_bf16 v14, v87, v21
    v_dot2c_f32_bf16 v15, v87, v17
    v_dot2c_f32_bf16 v8, v88, v22
    v_dot2c_f32_bf16 v9, v88, v18
    v_dot2c_f32_bf16 v10, v89, v22
    v_dot2c_f32_bf16 v11, v89, v18
    v_dot2c_f32_bf16 v12, v90, v22
    v_dot2c_f32_bf16 v13, v90, v18
    v_dot2c_f32_bf16 v14, v91, v22
    v_dot2c_f32_bf16 v15, v91, v18
    v_dot2c_f32_bf16 v8, v92, v23
    v_dot2c_f32_bf16 v9, v92, v19
    v_dot2c_f32_bf16 v10, v93, v23
    v_dot2c_f32_bf16 v11, v93, v19
    v_dot2c_f32_bf16 v12, v94, v23
    v_dot2c_f32_bf16 v13, v94, v19
    v_dot2c_f32_bf16 v14, v95, v23
    v_dot2c_f32_bf16 v15, v95, v19
    ds_read_b128 v[16:19], v5 offset:12864
    s_waitcnt vmcnt(12)
    s_waitcnt lgkmcnt(0)
    v_lshrrev_b32 v20, 16, v16
    v_lshrrev_b32 v21, 16, v17
    v_lshrrev_b32 v22, 16, v18
    v_lshrrev_b32 v23, 16, v19
    v_dot2c_f32_bf16 v8, v96, v20
    v_dot2c_f32_bf16 v9, v96, v16
    v_dot2c_f32_bf16 v10, v97, v20
    v_dot2c_f32_bf16 v11, v97, v16
    v_dot2c_f32_bf16 v12, v98, v20
    v_dot2c_f32_bf16 v13, v98, v16
    v_dot2c_f32_bf16 v14, v99, v20
    v_dot2c_f32_bf16 v15, v99, v16
    v_dot2c_f32_bf16 v8, v100, v21
    v_dot2c_f32_bf16 v9, v100, v17
    v_dot2c_f32_bf16 v10, v101, v21
    v_dot2c_f32_bf16 v11, v101, v17
    v_dot2c_f32_bf16 v12, v102, v21
    v_dot2c_f32_bf16 v13, v102, v17
    v_dot2c_f32_bf16 v14, v103, v21
    v_dot2c_f32_bf16 v15, v103, v17
    v_dot2c_f32_bf16 v8, v104, v22
    v_dot2c_f32_bf16 v9, v104, v18
    v_dot2c_f32_bf16 v10, v105, v22
    v_dot2c_f32_bf16 v11, v105, v18
    v_dot2c_f32_bf16 v12, v106, v22
    v_dot2c_f32_bf16 v13, v106, v18
    v_dot2c_f32_bf16 v14, v107, v22
    v_dot2c_f32_bf16 v15, v107, v18
    v_dot2c_f32_bf16 v8, v108, v23
    v_dot2c_f32_bf16 v9, v108, v19
    v_dot2c_f32_bf16 v10, v109, v23
    v_dot2c_f32_bf16 v11, v109, v19
    v_dot2c_f32_bf16 v12, v110, v23
    v_dot2c_f32_bf16 v13, v110, v19
    v_dot2c_f32_bf16 v14, v111, v23
    v_dot2c_f32_bf16 v15, v111, v19
    ds_read_b128 v[16:19], v5 offset:12880
    s_waitcnt vmcnt(8)
    s_waitcnt lgkmcnt(0)
    v_lshrrev_b32 v20, 16, v16
    v_lshrrev_b32 v21, 16, v17
    v_lshrrev_b32 v22, 16, v18
    v_lshrrev_b32 v23, 16, v19
    v_dot2c_f32_bf16 v8, v112, v20
    v_dot2c_f32_bf16 v9, v112, v16
    v_dot2c_f32_bf16 v10, v113, v20
    v_dot2c_f32_bf16 v11, v113, v16
    v_dot2c_f32_bf16 v12, v114, v20
    v_dot2c_f32_bf16 v13, v114, v16
    v_dot2c_f32_bf16 v14, v115, v20
    v_dot2c_f32_bf16 v15, v115, v16
    v_dot2c_f32_bf16 v8, v116, v21
    v_dot2c_f32_bf16 v9, v116, v17
    v_dot2c_f32_bf16 v10, v117, v21
    v_dot2c_f32_bf16 v11, v117, v17
    v_dot2c_f32_bf16 v12, v118, v21
    v_dot2c_f32_bf16 v13, v118, v17
    v_dot2c_f32_bf16 v14, v119, v21
    v_dot2c_f32_bf16 v15, v119, v17
    v_dot2c_f32_bf16 v8, v120, v22
    v_dot2c_f32_bf16 v9, v120, v18
    v_dot2c_f32_bf16 v10, v121, v22
    v_dot2c_f32_bf16 v11, v121, v18
    v_dot2c_f32_bf16 v12, v122, v22
    v_dot2c_f32_bf16 v13, v122, v18
    v_dot2c_f32_bf16 v14, v123, v22
    v_dot2c_f32_bf16 v15, v123, v18
    v_dot2c_f32_bf16 v8, v124, v23
    v_dot2c_f32_bf16 v9, v124, v19
    v_dot2c_f32_bf16 v10, v125, v23
    v_dot2c_f32_bf16 v11, v125, v19
    v_dot2c_f32_bf16 v12, v126, v23
    v_dot2c_f32_bf16 v13, v126, v19
    v_dot2c_f32_bf16 v14, v127, v23
    v_dot2c_f32_bf16 v15, v127, v19
    ds_read_b128 v[16:19], v5 offset:12896
    s_waitcnt vmcnt(4)
    s_waitcnt lgkmcnt(0)
    v_lshrrev_b32 v20, 16, v16
    v_lshrrev_b32 v21, 16, v17
    v_lshrrev_b32 v22, 16, v18
    v_lshrrev_b32 v23, 16, v19
    v_dot2c_f32_bf16 v8, v128, v20
    v_dot2c_f32_bf16 v9, v128, v16
    v_dot2c_f32_bf16 v10, v129, v20
    v_dot2c_f32_bf16 v11, v129, v16
    v_dot2c_f32_bf16 v12, v130, v20
    v_dot2c_f32_bf16 v13, v130, v16
    v_dot2c_f32_bf16 v14, v131, v20
    v_dot2c_f32_bf16 v15, v131, v16
    v_dot2c_f32_bf16 v8, v132, v21
    v_dot2c_f32_bf16 v9, v132, v17
    v_dot2c_f32_bf16 v10, v133, v21
    v_dot2c_f32_bf16 v11, v133, v17
    v_dot2c_f32_bf16 v12, v134, v21
    v_dot2c_f32_bf16 v13, v134, v17
    v_dot2c_f32_bf16 v14, v135, v21
    v_dot2c_f32_bf16 v15, v135, v17
    v_dot2c_f32_bf16 v8, v136, v22
    v_dot2c_f32_bf16 v9, v136, v18
    v_dot2c_f32_bf16 v10, v137, v22
    v_dot2c_f32_bf16 v11, v137, v18
    v_dot2c_f32_bf16 v12, v138, v22
    v_dot2c_f32_bf16 v13, v138, v18
    v_dot2c_f32_bf16 v14, v139, v22
    v_dot2c_f32_bf16 v15, v139, v18
    v_dot2c_f32_bf16 v8, v140, v23
    v_dot2c_f32_bf16 v9, v140, v19
    v_dot2c_f32_bf16 v10, v141, v23
    v_dot2c_f32_bf16 v11, v141, v19
    v_dot2c_f32_bf16 v12, v142, v23
    v_dot2c_f32_bf16 v13, v142, v19
    v_dot2c_f32_bf16 v14, v143, v23
    v_dot2c_f32_bf16 v15, v143, v19
    ds_read_b128 v[16:19], v5 offset:12912
    s_waitcnt vmcnt(0)
    s_waitcnt lgkmcnt(0)
    v_lshrrev_b32 v20, 16, v16
    v_lshrrev_b32 v21, 16, v17
    v_lshrrev_b32 v22, 16, v18
    v_lshrrev_b32 v23, 16, v19
    v_dot2c_f32_bf16 v8, v144, v20
    v_dot2c_f32_bf16 v9, v144, v16
    v_dot2c_f32_bf16 v10, v145, v20
    v_dot2c_f32_bf16 v11, v145, v16
    v_dot2c_f32_bf16 v12, v146, v20
    v_dot2c_f32_bf16 v13, v146, v16
    v_dot2c_f32_bf16 v14, v147, v20
    v_dot2c_f32_bf16 v15, v147, v16
    v_dot2c_f32_bf16 v8, v148, v21
    v_dot2c_f32_bf16 v9, v148, v17
    v_dot2c_f32_bf16 v10, v149, v21
    v_dot2c_f32_bf16 v11, v149, v17
    v_dot2c_f32_bf16 v12, v150, v21
    v_dot2c_f32_bf16 v13, v150, v17
    v_dot2c_f32_bf16 v14, v151, v21
    v_dot2c_f32_bf16 v15, v151, v17
    v_dot2c_f32_bf16 v8, v152, v22
    v_dot2c_f32_bf16 v9, v152, v18
    v_dot2c_f32_bf16 v10, v153, v22
    v_dot2c_f32_bf16 v11, v153, v18
    v_dot2c_f32_bf16 v12, v154, v22
    v_dot2c_f32_bf16 v13, v154, v18
    v_dot2c_f32_bf16 v14, v155, v22
    v_dot2c_f32_bf16 v15, v155, v18
    v_dot2c_f32_bf16 v8, v156, v23
    v_dot2c_f32_bf16 v9, v156, v19
    v_dot2c_f32_bf16 v10, v157, v23
    v_dot2c_f32_bf16 v11, v157, v19
    v_dot2c_f32_bf16 v12, v158, v23
    v_dot2c_f32_bf16 v13, v158, v19
    v_dot2c_f32_bf16 v14, v159, v23
    v_dot2c_f32_bf16 v15, v159, v19
    s_cmp_eq_u32 s3, 3
    s_cbranch_scc0 L_noadd_4
    v_mov_b32 v16, 0
    v_mov_b32 v17, 1
    s_mov_b64 exec, 1
    global_atomic_add v16, v17, s[36:37]
    s_mov_b64 exec, -1
L_noadd_4:
    v_permlane32_swap_b32 v8, v12
    v_permlane32_swap_b32 v9, v13
    v_permlane32_swap_b32 v10, v14
    v_permlane32_swap_b32 v11, v15
    v_add_f32 v8, v8, v12
    v_add_f32 v9, v9, v13
    v_add_f32 v10, v10, v14
    v_add_f32 v11, v11, v15
    s_nop 0
    v_permlane16_swap_b32 v8, v10
    v_permlane16_swap_b32 v9, v11
    v_add_f32 v8, v8, v10
    v_add_f32 v9, v9, v11
    v_lshlrev_b32 v5, 5, v3
    v_lshl_add_u32 v5, v2, 3, v5
    s_lshl_b32 s10, s3, 9
    v_add_u32 v6, s10, v5
    ds_write_b64 v6, v[8:9] offset:14848
    v_mov_b32 v6, 0
    v_mov_b32 v7, 8
    ds_write_b32 v6, v7 offset:320
    s_waitcnt lgkmcnt(0)
    s_barrier
    v_mov_b32 v30, 0x7fc00000
    v_mov_b32 v29, 0x7fc07fc0
    v_lshl_add_u32 v5, v3, 2, s12
    global_load_dword v160, v5, s[16:17]
    v_lshrrev_b32 v5, 1, v1
    v_and_b32 v6, 1, v1
    s_cmp_eq_u32 s94, 1
    s_cbranch_scc1 L_ldgu_5
    s_mov_b32 s52, s32
    s_and_b32 s53, s33, 0xffff
    s_mov_b32 s54, 1409024
    s_mov_b32 s55, 0x20000
    s_mov_b32 s56, s32
    s_and_b32 s57, s33, 0xffff
    s_mov_b32 s58, 1409024
    s_mov_b32 s59, 0x20000
    s_mul_i32 s10, s3, 352
    v_add_u32 v4, s10, v5
    v_lshlrev_b32 v4, 10, v4
    s_branch L_ldend_6
L_ldgu_5:
    s_nop 1
    s_mov_b32 s52, s28
    s_and_b32 s53, s29, 0xffff
    s_mov_b32 s54, 1409024
    s_mov_b32 s55, 0x20000
    s_mov_b32 s56, s30
    s_and_b32 s57, s31, 0xffff
    s_mov_b32 s58, 1409024
    s_mov_b32 s59, 0x20000
    s_lshl_b32 s10, s3, 7
    v_add_u32 v4, s10, v5
    v_mul_u32_u24 v4, 2752, v4
L_ldend_6:
    s_nop 2
    v_lshl_add_u32 v4, v6, 4, v4
    s_lshl_b32 s10, s95, 5
    v_add_u32 v167, s10, v4
    v_mov_b32 v6, 0
L_wow_7:
    s_nop 2
    ds_read_b32 v7, v6 offset:320
    s_waitcnt lgkmcnt(0)
    v_readfirstlane_b32 s10, v7
    s_nop 3
    s_cmp_ge_u32 s10, 24
    s_cbranch_scc1 L_wowdone_8
    s_sleep 8
    s_branch L_wow_7
L_wowdone_8:
    s_lshl_b32 s10, s6, 7
    s_lshl_b32 s11, s3, 5
    s_add_u32 s10, s10, s11
    s_lshl_b32 s10, s10, 10
    v_lshl_add_u32 v4, v1, 4, s10
    s_mov_b32 s10, 0
    buffer_load_dwordx4 v[32:35], v4, s[44:47], s10 offen offset:0 nt
    buffer_load_dwordx4 v[36:39], v4, s[44:47], s10 offen offset:1024 nt
    buffer_load_dwordx4 v[40:43], v4, s[44:47], s10 offen offset:2048 nt
    buffer_load_dwordx4 v[44:47], v4, s[44:47], s10 offen offset:3072 nt
    s_mov_b32 s10, 4096
    buffer_load_dwordx4 v[48:51], v4, s[44:47], s10 offen offset:0 nt
    buffer_load_dwordx4 v[52:55], v4, s[44:47], s10 offen offset:1024 nt
    buffer_load_dwordx4 v[56:59], v4, s[44:47], s10 offen offset:2048 nt
    buffer_load_dwordx4 v[60:63], v4, s[44:47], s10 offen offset:3072 nt
    s_mov_b32 s10, 8192
    buffer_load_dwordx4 v[64:67], v4, s[44:47], s10 offen offset:0 nt
    buffer_load_dwordx4 v[68:71], v4, s[44:47], s10 offen offset:1024 nt
    buffer_load_dwordx4 v[72:75], v4, s[44:47], s10 offen offset:2048 nt
    buffer_load_dwordx4 v[76:79], v4, s[44:47], s10 offen offset:3072 nt
    s_mov_b32 s10, 12288
    buffer_load_dwordx4 v[80:83], v4, s[44:47], s10 offen offset:0 nt
    buffer_load_dwordx4 v[84:87], v4, s[44:47], s10 offen offset:1024 nt
    buffer_load_dwordx4 v[88:91], v4, s[44:47], s10 offen offset:2048 nt
    buffer_load_dwordx4 v[92:95], v4, s[44:47], s10 offen offset:3072 nt
    s_mov_b32 s10, 16384
    buffer_load_dwordx4 v[96:99], v4, s[44:47], s10 offen offset:0 nt
    buffer_load_dwordx4 v[100:103], v4, s[44:47], s10 offen offset:1024 nt
    buffer_load_dwordx4 v[104:107], v4, s[44:47], s10 offen offset:2048 nt
    buffer_load_dwordx4 v[108:111], v4, s[44:47], s10 offen offset:3072 nt
    s_mov_b32 s10, 20480
    buffer_load_dwordx4 v[112:115], v4, s[44:47], s10 offen offset:0 nt
    buffer_load_dwordx4 v[116:119], v4, s[44:47], s10 offen offset:1024 nt
    buffer_load_dwordx4 v[120:123], v4, s[44:47], s10 offen offset:2048 nt
    buffer_load_dwordx4 v[124:127], v4, s[44:47], s10 offen offset:3072 nt
    s_mov_b32 s10, 24576
    buffer_load_dwordx4 v[128:131], v4, s[44:47], s10 offen offset:0 nt
    buffer_load_dwordx4 v[132:135], v4, s[44:47], s10 offen offset:1024 nt
    buffer_load_dwordx4 v[136:139], v4, s[44:47], s10 offen offset:2048 nt
    buffer_load_dwordx4 v[140:143], v4, s[44:47], s10 offen offset:3072 nt
    s_mov_b32 s10, 28672
    buffer_load_dwordx4 v[144:147], v4, s[44:47], s10 offen offset:0 nt
    buffer_load_dwordx4 v[148:151], v4, s[44:47], s10 offen offset:1024 nt
    buffer_load_dwordx4 v[152:155], v4, s[44:47], s10 offen offset:2048 nt
    buffer_load_dwordx4 v[156:159], v4, s[44:47], s10 offen offset:3072 nt
    s_mov_b32 s10, 0x05040100
    s_mov_b32 s11, 0x07060302
    s_waitcnt vmcnt(30)
    v_perm_b32 v8, v36, v32, s10
    v_perm_b32 v36, v36, v32, s11
    v_perm_b32 v9, v37, v33, s10
    v_perm_b32 v37, v37, v33, s11
    v_perm_b32 v10, v38, v34, s10
    v_perm_b32 v38, v38, v34, s11
    v_perm_b32 v11, v39, v35, s10
    v_perm_b32 v39, v39, v35, s11
    v_mov_b32 v32, v8
    v_mov_b32 v33, v9
    v_mov_b32 v34, v10
    v_mov_b32 v35, v11
    s_waitcnt vmcnt(28)
    v_perm_b32 v8, v44, v40, s10
    v_perm_b32 v44, v44, v40, s11
    v_perm_b32 v9, v45, v41, s10
    v_perm_b32 v45, v45, v41, s11
    v_perm_b32 v10, v46, v42, s10
    v_perm_b32 v46, v46, v42, s11
    v_perm_b32 v11, v47, v43, s10
    v_perm_b32 v47, v47, v43, s11
    v_mov_b32 v40, v8
    v_mov_b32 v41, v9
    v_mov_b32 v42, v10
    v_mov_b32 v43, v11
    s_waitcnt vmcnt(26)
    v_perm_b32 v8, v52, v48, s10
    v_perm_b32 v52, v52, v48, s11
    v_perm_b32 v9, v53, v49, s10
    v_perm_b32 v53, v53, v49, s11
    v_perm_b32 v10, v54, v50, s10
    v_perm_b32 v54, v54, v50, s11
    v_perm_b32 v11, v55, v51, s10
    v_perm_b32 v55, v55, v51, s11
    v_mov_b32 v48, v8
    v_mov_b32 v49, v9
    v_mov_b32 v50, v10
    v_mov_b32 v51, v11
    s_waitcnt vmcnt(24)
    v_perm_b32 v8, v60, v56, s10
    v_perm_b32 v60, v60, v56, s11
    v_perm_b32 v9, v61, v57, s10
    v_perm_b32 v61, v61, v57, s11
    v_perm_b32 v10, v62, v58, s10
    v_perm_b32 v62, v62, v58, s11
    v_perm_b32 v11, v63, v59, s10
    v_perm_b32 v63, v63, v59, s11
    v_mov_b32 v56, v8
    v_mov_b32 v57, v9
    v_mov_b32 v58, v10
    v_mov_b32 v59, v11
    s_waitcnt vmcnt(22)
    v_perm_b32 v8, v68, v64, s10
    v_perm_b32 v68, v68, v64, s11
    v_perm_b32 v9, v69, v65, s10
    v_perm_b32 v69, v69, v65, s11
    v_perm_b32 v10, v70, v66, s10
    v_perm_b32 v70, v70, v66, s11
    v_perm_b32 v11, v71, v67, s10
    v_perm_b32 v71, v71, v67, s11
    v_mov_b32 v64, v8
    v_mov_b32 v65, v9
    v_mov_b32 v66, v10
    v_mov_b32 v67, v11
    s_waitcnt vmcnt(20)
    v_perm_b32 v8, v76, v72, s10
    v_perm_b32 v76, v76, v72, s11
    v_perm_b32 v9, v77, v73, s10
    v_perm_b32 v77, v77, v73, s11
    v_perm_b32 v10, v78, v74, s10
    v_perm_b32 v78, v78, v74, s11
    v_perm_b32 v11, v79, v75, s10
    v_perm_b32 v79, v79, v75, s11
    v_mov_b32 v72, v8
    v_mov_b32 v73, v9
    v_mov_b32 v74, v10
    v_mov_b32 v75, v11
    s_waitcnt vmcnt(18)
    v_perm_b32 v8, v84, v80, s10
    v_perm_b32 v84, v84, v80, s11
    v_perm_b32 v9, v85, v81, s10
    v_perm_b32 v85, v85, v81, s11
    v_perm_b32 v10, v86, v82, s10
    v_perm_b32 v86, v86, v82, s11
    v_perm_b32 v11, v87, v83, s10
    v_perm_b32 v87, v87, v83, s11
    v_mov_b32 v80, v8
    v_mov_b32 v81, v9
    v_mov_b32 v82, v10
    v_mov_b32 v83, v11
    s_waitcnt vmcnt(16)
    v_perm_b32 v8, v92, v88, s10
    v_perm_b32 v92, v92, v88, s11
    v_perm_b32 v9, v93, v89, s10
    v_perm_b32 v93, v93, v89, s11
    v_perm_b32 v10, v94, v90, s10
    v_perm_b32 v94, v94, v90, s11
    v_perm_b32 v11, v95, v91, s10
    v_perm_b32 v95, v95, v91, s11
    v_mov_b32 v88, v8
    v_mov_b32 v89, v9
    v_mov_b32 v90, v10
    v_mov_b32 v91, v11
    s_waitcnt vmcnt(14)
    v_perm_b32 v8, v100, v96, s10
    v_perm_b32 v100, v100, v96, s11
    v_perm_b32 v9, v101, v97, s10
    v_perm_b32 v101, v101, v97, s11
    v_perm_b32 v10, v102, v98, s10
    v_perm_b32 v102, v102, v98, s11
    v_perm_b32 v11, v103, v99, s10
    v_perm_b32 v103, v103, v99, s11
    v_mov_b32 v96, v8
    v_mov_b32 v97, v9
    v_mov_b32 v98, v10
    v_mov_b32 v99, v11
    s_waitcnt vmcnt(12)
    v_perm_b32 v8, v108, v104, s10
    v_perm_b32 v108, v108, v104, s11
    v_perm_b32 v9, v109, v105, s10
    v_perm_b32 v109, v109, v105, s11
    v_perm_b32 v10, v110, v106, s10
    v_perm_b32 v110, v110, v106, s11
    v_perm_b32 v11, v111, v107, s10
    v_perm_b32 v111, v111, v107, s11
    v_mov_b32 v104, v8
    v_mov_b32 v105, v9
    v_mov_b32 v106, v10
    v_mov_b32 v107, v11
    s_waitcnt vmcnt(10)
    v_perm_b32 v8, v116, v112, s10
    v_perm_b32 v116, v116, v112, s11
    v_perm_b32 v9, v117, v113, s10
    v_perm_b32 v117, v117, v113, s11
    v_perm_b32 v10, v118, v114, s10
    v_perm_b32 v118, v118, v114, s11
    v_perm_b32 v11, v119, v115, s10
    v_perm_b32 v119, v119, v115, s11
    v_mov_b32 v112, v8
    v_mov_b32 v113, v9
    v_mov_b32 v114, v10
    v_mov_b32 v115, v11
    s_waitcnt vmcnt(8)
    v_perm_b32 v8, v124, v120, s10
    v_perm_b32 v124, v124, v120, s11
    v_perm_b32 v9, v125, v121, s10
    v_perm_b32 v125, v125, v121, s11
    v_perm_b32 v10, v126, v122, s10
    v_perm_b32 v126, v126, v122, s11
    v_perm_b32 v11, v127, v123, s10
    v_perm_b32 v127, v127, v123, s11
    v_mov_b32 v120, v8
    v_mov_b32 v121, v9
    v_mov_b32 v122, v10
    v_mov_b32 v123, v11
    s_waitcnt vmcnt(6)
    v_perm_b32 v8, v132, v128, s10
    v_perm_b32 v132, v132, v128, s11
    v_perm_b32 v9, v133, v129, s10
    v_perm_b32 v133, v133, v129, s11
    v_perm_b32 v10, v134, v130, s10
    v_perm_b32 v134, v134, v130, s11
    v_perm_b32 v11, v135, v131, s10
    v_perm_b32 v135, v135, v131, s11
    v_mov_b32 v128, v8
    v_mov_b32 v129, v9
    v_mov_b32 v130, v10
    v_mov_b32 v131, v11
    s_waitcnt vmcnt(4)
    v_perm_b32 v8, v140, v136, s10
    v_perm_b32 v140, v140, v136, s11
    v_perm_b32 v9, v141, v137, s10
    v_perm_b32 v141, v141, v137, s11
    v_perm_b32 v10, v142, v138, s10
    v_perm_b32 v142, v142, v138, s11
    v_perm_b32 v11, v143, v139, s10
    v_perm_b32 v143, v143, v139, s11
    v_mov_b32 v136, v8
    v_mov_b32 v137, v9
    v_mov_b32 v138, v10
    v_mov_b32 v139, v11
    s_waitcnt vmcnt(2)
    v_perm_b32 v8, v148, v144, s10
    v_perm_b32 v148, v148, v144, s11
    v_perm_b32 v9, v149, v145, s10
    v_perm_b32 v149, v149, v145, s11
    v_perm_b32 v10, v150, v146, s10
    v_perm_b32 v150, v150, v146, s11
    v_perm_b32 v11, v151, v147, s10
    v_perm_b32 v151, v151, v147, s11
    v_mov_b32 v144, v8
    v_mov_b32 v145, v9
    v_mov_b32 v146, v10
    v_mov_b32 v147, v11
    s_waitcnt vmcnt(0)
    v_perm_b32 v8, v156, v152, s10
    v_perm_b32 v156, v156, v152, s11
    v_perm_b32 v9, v157, v153, s10
    v_perm_b32 v157, v157, v153, s11
    v_perm_b32 v10, v158, v154, s10
    v_perm_b32 v158, v158, v154, s11
    v_perm_b32 v11, v159, v155, s10
    v_perm_b32 v159, v159, v155, s11
    v_mov_b32 v152, v8
    v_mov_b32 v153, v9
    v_mov_b32 v154, v10
    v_mov_b32 v155, v11
    v_mov_b32 v6, 0
    v_and_b32 v4, 31, v1
    s_lshl_b32 s10, s3, 7
    v_lshl_add_u32 v5, v4, 2, s10
    s_barrier
    v_mov_b32 v31, 0x100
    s_cmp_eq_u32 s3, 0
    s_cbranch_scc0 L_nock_9
    s_cmp_eq_u32 s94, 0
    s_cbranch_scc1 L_nock_9
    global_load_dword v31, v6, s[36:37] sc1
L_nock_9:
    ds_read_b128 v[8:11], v6 offset:256
    ds_read_b128 v[12:15], v6 offset:272
    ds_read_b128 v[16:19], v6 offset:288
    ds_read_b128 v[20:23], v6 offset:304
    ds_read_b32 v24, v5 offset:512
    ds_read_b32 v25, v5 offset:1024
    ds_read_b32 v26, v5 offset:1536
    ds_read_b32 v27, v5 offset:2048
    ds_read_b32 v28, v5 offset:2560
    ds_read_b32 v166, v5 offset:3072
    ds_read_b32 v4, v5 offset:3584
    ds_read_b32 v7, v5 offset:4096
    s_waitcnt lgkmcnt(0)
    v_max3_f32 v164, v8, v10, v12
    v_max3_f32 v165, v14, v16, v18
    v_max3_f32 v164, v164, v20, v22
    v_max_f32 v164, v164, v165
    v_sub_f32 v8, v8, v164
    v_sub_f32 v10, v10, v164
    v_sub_f32 v12, v12, v164
    v_sub_f32 v14, v14, v164
    v_sub_f32 v16, v16, v164
    v_sub_f32 v18, v18, v164
    v_sub_f32 v20, v20, v164
    v_sub_f32 v22, v22, v164
    v_mul_f32 v8, s96, v8
    v_mul_f32 v10, s96, v10
    v_mul_f32 v12, s96, v12
    v_mul_f32 v14, s96, v14
    v_mul_f32 v16, s96, v16
    v_mul_f32 v18, s96, v18
    v_mul_f32 v20, s96, v20
    v_mul_f32 v22, s96, v22
    v_exp_f32 v8, v8
    v_exp_f32 v10, v10
    v_exp_f32 v12, v12
    v_exp_f32 v14, v14
    v_exp_f32 v16, v16
    v_exp_f32 v18, v18
    v_exp_f32 v20, v20
    v_exp_f32 v22, v22
    v_mul_f32 v165, v8, v9
    v_mul_f32 v9, v8, v24
    v_fmac_f32 v165, v10, v11
    v_fmac_f32 v9, v10, v25
    v_fmac_f32 v165, v12, v13
    v_fmac_f32 v9, v12, v26
    v_fmac_f32 v165, v14, v15
    v_fmac_f32 v9, v14, v27
    v_fmac_f32 v165, v16, v17
    v_fmac_f32 v9, v16, v28
    v_fmac_f32 v165, v18, v19
    v_fmac_f32 v9, v18, v166
    v_fmac_f32 v165, v20, v21
    v_fmac_f32 v9, v20, v4
    v_fmac_f32 v165, v22, v23
    v_fmac_f32 v9, v22, v7
    v_rcp_f32 v27, v165
    s_nop 0
    v_mul_f32 v26, v9, v27
    s_nop 1
    v_mov_b32_dpp v27, v26 quad_perm:[1,0,3,2] row_mask:0xf bank_mask:0xf
    v_cvt_pk_bf16_f32 v26, v26, v27
    v_mov_b32 v24, v164
    v_mov_b32 v25, v165
    v_mov_b32 v8, 0
    v_mov_b32 v9, 0
    v_mov_b32 v10, 0
    v_mov_b32 v11, 0
    v_mov_b32 v12, 0
    v_mov_b32 v13, 0
    v_mov_b32 v14, 0
    v_mov_b32 v15, 0
    v_readlane_b32 s60, v26, 0
    v_readlane_b32 s61, v26, 2
    v_readlane_b32 s62, v26, 4
    v_readlane_b32 s63, v26, 6
    v_readlane_b32 s64, v26, 8
    v_readlane_b32 s65, v26, 10
    v_readlane_b32 s66, v26, 12
    v_readlane_b32 s67, v26, 14
    v_readlane_b32 s68, v26, 16
    v_readlane_b32 s69, v26, 18
    v_readlane_b32 s70, v26, 20
    v_readlane_b32 s71, v26, 22
    v_readlane_b32 s72, v26, 24
    v_readlane_b32 s73, v26, 26
    v_readlane_b32 s74, v26, 28
    v_readlane_b32 s75, v26, 30
    v_dot2c_f32_bf16 v8, s60, v32
    v_dot2c_f32_bf16 v9, s60, v36
    v_dot2c_f32_bf16 v10, s60, v33
    v_dot2c_f32_bf16 v11, s60, v37
    v_dot2c_f32_bf16 v12, s60, v34
    v_dot2c_f32_bf16 v13, s60, v38
    v_dot2c_f32_bf16 v14, s60, v35
    v_dot2c_f32_bf16 v15, s60, v39
    v_dot2c_f32_bf16 v8, s61, v40
    v_dot2c_f32_bf16 v9, s61, v44
    v_dot2c_f32_bf16 v10, s61, v41
    v_dot2c_f32_bf16 v11, s61, v45
    v_dot2c_f32_bf16 v12, s61, v42
    v_dot2c_f32_bf16 v13, s61, v46
    v_dot2c_f32_bf16 v14, s61, v43
    v_dot2c_f32_bf16 v15, s61, v47
    v_dot2c_f32_bf16 v8, s62, v48
    v_dot2c_f32_bf16 v9, s62, v52
    v_dot2c_f32_bf16 v10, s62, v49
    v_dot2c_f32_bf16 v11, s62, v53
    v_dot2c_f32_bf16 v12, s62, v50
    v_dot2c_f32_bf16 v13, s62, v54
    v_dot2c_f32_bf16 v14, s62, v51
    v_dot2c_f32_bf16 v15, s62, v55
    v_dot2c_f32_bf16 v8, s63, v56
    v_dot2c_f32_bf16 v9, s63, v60
    v_dot2c_f32_bf16 v10, s63, v57
    v_dot2c_f32_bf16 v11, s63, v61
    v_dot2c_f32_bf16 v12, s63, v58
    v_dot2c_f32_bf16 v13, s63, v62
    v_dot2c_f32_bf16 v14, s63, v59
    v_dot2c_f32_bf16 v15, s63, v63
    v_dot2c_f32_bf16 v8, s64, v64
    v_dot2c_f32_bf16 v9, s64, v68
    v_dot2c_f32_bf16 v10, s64, v65
    v_dot2c_f32_bf16 v11, s64, v69
    v_dot2c_f32_bf16 v12, s64, v66
    v_dot2c_f32_bf16 v13, s64, v70
    v_dot2c_f32_bf16 v14, s64, v67
    v_dot2c_f32_bf16 v15, s64, v71
    v_dot2c_f32_bf16 v8, s65, v72
    v_dot2c_f32_bf16 v9, s65, v76
    v_dot2c_f32_bf16 v10, s65, v73
    v_dot2c_f32_bf16 v11, s65, v77
    v_dot2c_f32_bf16 v12, s65, v74
    v_dot2c_f32_bf16 v13, s65, v78
    v_dot2c_f32_bf16 v14, s65, v75
    v_dot2c_f32_bf16 v15, s65, v79
    v_dot2c_f32_bf16 v8, s66, v80
    v_dot2c_f32_bf16 v9, s66, v84
    v_dot2c_f32_bf16 v10, s66, v81
    v_dot2c_f32_bf16 v11, s66, v85
    v_dot2c_f32_bf16 v12, s66, v82
    v_dot2c_f32_bf16 v13, s66, v86
    v_dot2c_f32_bf16 v14, s66, v83
    v_dot2c_f32_bf16 v15, s66, v87
    v_dot2c_f32_bf16 v8, s67, v88
    v_dot2c_f32_bf16 v9, s67, v92
    v_dot2c_f32_bf16 v10, s67, v89
    v_dot2c_f32_bf16 v11, s67, v93
    v_dot2c_f32_bf16 v12, s67, v90
    v_dot2c_f32_bf16 v13, s67, v94
    v_dot2c_f32_bf16 v14, s67, v91
    v_dot2c_f32_bf16 v15, s67, v95
    v_dot2c_f32_bf16 v8, s68, v96
    v_dot2c_f32_bf16 v9, s68, v100
    v_dot2c_f32_bf16 v10, s68, v97
    v_dot2c_f32_bf16 v11, s68, v101
    v_dot2c_f32_bf16 v12, s68, v98
    v_dot2c_f32_bf16 v13, s68, v102
    v_dot2c_f32_bf16 v14, s68, v99
    v_dot2c_f32_bf16 v15, s68, v103
    v_dot2c_f32_bf16 v8, s69, v104
    v_dot2c_f32_bf16 v9, s69, v108
    v_dot2c_f32_bf16 v10, s69, v105
    v_dot2c_f32_bf16 v11, s69, v109
    v_dot2c_f32_bf16 v12, s69, v106
    v_dot2c_f32_bf16 v13, s69, v110
    v_dot2c_f32_bf16 v14, s69, v107
    v_dot2c_f32_bf16 v15, s69, v111
    v_dot2c_f32_bf16 v8, s70, v112
    v_dot2c_f32_bf16 v9, s70, v116
    v_dot2c_f32_bf16 v10, s70, v113
    v_dot2c_f32_bf16 v11, s70, v117
    v_dot2c_f32_bf16 v12, s70, v114
    v_dot2c_f32_bf16 v13, s70, v118
    v_dot2c_f32_bf16 v14, s70, v115
    v_dot2c_f32_bf16 v15, s70, v119
    v_dot2c_f32_bf16 v8, s71, v120
    v_dot2c_f32_bf16 v9, s71, v124
    v_dot2c_f32_bf16 v10, s71, v121
    v_dot2c_f32_bf16 v11, s71, v125
    v_dot2c_f32_bf16 v12, s71, v122
    v_dot2c_f32_bf16 v13, s71, v126
    v_dot2c_f32_bf16 v14, s71, v123
    v_dot2c_f32_bf16 v15, s71, v127
    v_dot2c_f32_bf16 v8, s72, v128
    v_dot2c_f32_bf16 v9, s72, v132
    v_dot2c_f32_bf16 v10, s72, v129
    v_dot2c_f32_bf16 v11, s72, v133
    v_dot2c_f32_bf16 v12, s72, v130
    v_dot2c_f32_bf16 v13, s72, v134
    v_dot2c_f32_bf16 v14, s72, v131
    v_dot2c_f32_bf16 v15, s72, v135
    v_dot2c_f32_bf16 v8, s73, v136
    v_dot2c_f32_bf16 v9, s73, v140
    v_dot2c_f32_bf16 v10, s73, v137
    v_dot2c_f32_bf16 v11, s73, v141
    v_dot2c_f32_bf16 v12, s73, v138
    v_dot2c_f32_bf16 v13, s73, v142
    v_dot2c_f32_bf16 v14, s73, v139
    v_dot2c_f32_bf16 v15, s73, v143
    v_dot2c_f32_bf16 v8, s74, v144
    v_dot2c_f32_bf16 v9, s74, v148
    v_dot2c_f32_bf16 v10, s74, v145
    v_dot2c_f32_bf16 v11, s74, v149
    v_dot2c_f32_bf16 v12, s74, v146
    v_dot2c_f32_bf16 v13, s74, v150
    v_dot2c_f32_bf16 v14, s74, v147
    v_dot2c_f32_bf16 v15, s74, v151
    v_dot2c_f32_bf16 v8, s75, v152
    v_dot2c_f32_bf16 v9, s75, v156
    v_dot2c_f32_bf16 v10, s75, v153
    v_dot2c_f32_bf16 v11, s75, v157
    v_dot2c_f32_bf16 v12, s75, v154
    v_dot2c_f32_bf16 v13, s75, v158
    v_dot2c_f32_bf16 v14, s75, v155
    v_dot2c_f32_bf16 v15, s75, v159
    s_lshl_b32 s10, s3, 11
    v_lshl_add_u32 v5, v1, 5, s10
    ds_write_b128 v5, v[8:11] offset:4608
    ds_write_b128 v5, v[12:15] offset:4624
    s_waitcnt lgkmcnt(0)
    s_barrier
    s_cmp_eq_u32 s3, 0
    s_cbranch_scc1 L_pubdone_13
    s_cmp_lt_u32 s3, 2
    s_cbranch_scc1 L_ml_12
    s_sub_u32 s10, s3, 2
    s_lshl_b32 s10, s10, 10
    v_lshl_add_u32 v5, v1, 4, s10
    ds_read_b128 v[8:11], v5 offset:4608
    ds_read_b128 v[12:15], v5 offset:6656
    ds_read_b128 v[16:19], v5 offset:8704
    ds_read_b128 v[20:23], v5 offset:10752
    s_waitcnt lgkmcnt(0)
    v_add_f32 v8, v8, v12
    v_add_f32 v16, v16, v20
    v_add_f32 v9, v9, v13
    v_add_f32 v17, v17, v21
    v_add_f32 v10, v10, v14
    v_add_f32 v18, v18, v22
    v_add_f32 v11, v11, v15
    v_add_f32 v19, v19, v23
    v_add_f32 v8, v8, v16
    v_add_f32 v9, v9, v17
    v_add_f32 v10, v10, v18
    v_add_f32 v11, v11, v19
    v_cmp_eq_u32 vcc, -1, v8
    s_nop 1
    v_cndmask_b32 v8, v8, v30, vcc
    v_cmp_eq_u32 vcc, -1, v9
    s_nop 1
    v_cndmask_b32 v9, v9, v30, vcc
    v_cmp_eq_u32 vcc, -1, v10
    s_nop 1
    v_cndmask_b32 v10, v10, v30, vcc
    v_cmp_eq_u32 vcc, -1, v11
    s_nop 1
    v_cndmask_b32 v11, v11, v30, vcc
    v_add_u32 v5, s93, v5
    buffer_store_dwordx4 v[8:11], v5, s[48:51], 0 offen sc1
    s_branch L_pubdone_13
L_ml_12:
    s_nop 0
    v_cmp_eq_u32 vcc, -1, v24
    s_nop 1
    v_cndmask_b32 v24, v24, v30, vcc
    v_cmp_eq_u32 vcc, -1, v25
    s_nop 1
    v_cndmask_b32 v25, v25, v30, vcc
    s_add_u32 s10, s93, 2048
    v_mov_b32 v6, s10
    s_mov_b64 exec, 1
    buffer_store_dwordx2 v[24:25], v6, s[48:51], 0 offen sc1
    s_mov_b64 exec, -1
L_pubdone_13:
    s_cmp_eq_u32 s94, 3
    s_cbranch_scc0 L_role2_11
    s_mov_b32 s14, 0
    s_waitcnt vmcnt(0)
L_cnt_14:
    v_cmp_gt_u32 vcc, 0x100, v31
    s_nop 4
    s_cbranch_vccz L_cntdone_15
    s_add_u32 s14, s14, 1
    s_cmp_gt_u32 s14, 100000
    s_cbranch_scc1 L_cntdone_15
    s_sleep 32
    v_mov_b32 v31, 0
    global_load_dword v31, v31, s[36:37] sc1
    s_waitcnt vmcnt(0)
    s_branch L_cnt_14
L_cntdone_15:
    s_barrier
    s_lshr_b32 s10, s95, 4
    s_lshl_b32 s10, s10, 18
    s_lshl_b32 s11, s3, 16
    s_add_u32 s10, s10, s11
    v_lshrrev_b32 v6, 3, v1
    v_and_b32 v5, 1, v1
    v_lshl_add_u32 v6, v6, 1, v5
    v_lshl_add_u32 v6, v6, 12, s10
    s_and_b32 s11, s95, 15
    s_lshl_b32 s11, s11, 7
    v_bfe_u32 v23, v1, 1, 2
    v_lshl_add_u32 v5, v23, 5, v6
    v_add_u32 v5, s11, v5
    s_mov_b32 s14, 0
L_poll_16:
    s_nop 1
    buffer_load_dwordx4 v[32:35], v5, s[48:51], 0 offen sc1
    buffer_load_dwordx4 v[36:39], v5, s[48:51], 0 offen offset:16 sc1
    buffer_load_dwordx2 v[16:17], v6, s[48:51], 0 offen offset:2048 sc1
    s_waitcnt vmcnt(0)
    v_max3_u32 v18, v32, v33, v34
    v_max3_u32 v18, v18, v35, v36
    v_max3_u32 v18, v18, v37, v38
    v_max3_u32 v18, v18, v39, v16
    v_max_u32 v18, v18, v17
    v_cmp_eq_u32 vcc, -1, v18
    s_nop 4
    s_cbranch_vccz L_polldone_17
    s_add_u32 s14, s14, 1
    s_cmp_gt_u32 s14, 400000
    s_cbranch_scc1 L_polldone_17
    s_sleep 0
    s_branch L_poll_16
L_polldone_17:
    v_mov_b32_dpp v18, v16 quad_perm:[1,0,3,2] row_mask:0xf bank_mask:0xf
    v_mov_b32_dpp v19, v17 quad_perm:[1,0,3,2] row_mask:0xf bank_mask:0xf
    v_max_f32 v20, v16, v18
    v_sub_f32 v16, v16, v20
    v_sub_f32 v18, v18, v20
    v_mul_f32 v16, s96, v16
    v_mul_f32 v18, s96, v18
    v_exp_f32 v16, v16
    v_exp_f32 v18, v18
    v_mul_f32 v16, v16, v17
    v_mul_f32 v18, v18, v19
    v_add_f32 v18, v16, v18
    v_rcp_f32 v18, v18
    s_nop 0
    v_mul_f32 v16, v16, v18
    v_mul_f32 v32, v32, v16
    v_mul_f32 v33, v33, v16
    v_mul_f32 v34, v34, v16
    v_mul_f32 v35, v35, v16
    v_mul_f32 v36, v36, v16
    v_mul_f32 v37, v37, v16
    v_mul_f32 v38, v38, v16
    v_mul_f32 v39, v39, v16
    v_add_f32 v32, v32, v32 quad_perm:[1,0,3,2] row_mask:0xf bank_mask:0xf
    v_add_f32 v33, v33, v33 quad_perm:[1,0,3,2] row_mask:0xf bank_mask:0xf
    v_add_f32 v34, v34, v34 quad_perm:[1,0,3,2] row_mask:0xf bank_mask:0xf
    v_add_f32 v35, v35, v35 quad_perm:[1,0,3,2] row_mask:0xf bank_mask:0xf
    v_add_f32 v36, v36, v36 quad_perm:[1,0,3,2] row_mask:0xf bank_mask:0xf
    v_add_f32 v37, v37, v37 quad_perm:[1,0,3,2] row_mask:0xf bank_mask:0xf
    v_add_f32 v38, v38, v38 quad_perm:[1,0,3,2] row_mask:0xf bank_mask:0xf
    v_add_f32 v39, v39, v39 quad_perm:[1,0,3,2] row_mask:0xf bank_mask:0xf
    v_add_f32 v32, v32, v32 row_ror:8
    v_add_f32 v33, v33, v33 row_ror:8
    v_add_f32 v34, v34, v34 row_ror:8
    v_add_f32 v35, v35, v35 row_ror:8
    v_add_f32 v36, v36, v36 row_ror:8
    v_add_f32 v37, v37, v37 row_ror:8
    v_add_f32 v38, v38, v38 row_ror:8
    v_add_f32 v39, v39, v39 row_ror:8
    v_permlane32_swap_b32 v32, v36
    v_permlane32_swap_b32 v33, v37
    v_permlane32_swap_b32 v34, v38
    v_permlane32_swap_b32 v35, v39
    v_add_f32 v32, v32, v36
    v_add_f32 v33, v33, v37
    v_add_f32 v34, v34, v38
    v_add_f32 v35, v35, v39
    s_nop 0
    v_permlane16_swap_b32 v32, v34
    v_permlane16_swap_b32 v33, v35
    v_add_f32 v32, v32, v34
    v_add_f32 v33, v33, v35
    v_lshlrev_b32 v5, 5, v23
    v_lshl_add_u32 v5, v2, 3, v5
    s_lshl_b32 s10, s3, 7
    v_add_u32 v5, s10, v5
    ds_write_b64 v5, v[32:33] offset:12800
    s_waitcnt lgkmcnt(0)
    s_barrier
    s_cmp_eq_u32 s3, 0
    s_cbranch_scc0 L_role2_11
    v_lshlrev_b32 v5, 3, v3
    ds_read_b64 v[8:9], v5 offset:12800
    ds_read_b64 v[10:11], v5 offset:12928
    ds_read_b64 v[12:13], v5 offset:13056
    ds_read_b64 v[14:15], v5 offset:13184
    v_lshl_add_u32 v5, v3, 2, s13
    s_waitcnt lgkmcnt(0)
    v_add_f32 v8, v8, v10
    v_add_f32 v12, v12, v14
    v_add_f32 v9, v9, v11
    v_add_f32 v13, v13, v15
    v_add_f32 v8, v8, v12
    v_add_f32 v9, v9, v13
    v_cvt_pk_bf16_f32 v17, v8, v9
    v_lshlrev_b32 v8, 16, v17
    v_and_b32 v9, 0xffff0000, v17
    v_lshlrev_b32 v10, 16, v160
    v_and_b32 v11, 0xffff0000, v160
    v_add_f32 v8, v8, v10
    v_add_f32 v9, v9, v11
    v_cvt_pk_bf16_f32 v8, v8, v9
    v_cmp_eq_u32 vcc, -1, v8
    s_nop 1
    v_cndmask_b32 v8, v8, v29, vcc
    s_mov_b32 exec_lo, 0xffff
    s_mov_b32 exec_hi, 0
    buffer_store_dword v8, v5, s[48:51], 0 offen sc1
    s_mov_b64 exec, -1
L_role2_11:
    s_cmp_eq_u32 s94, 1
    s_cbranch_scc1 L_dgu_18
    s_cmp_eq_u32 s94, 2
    s_cbranch_scc1 L_ddn_19
    s_branch L_dend_20
L_dgu_18:
    s_lshl_b32 s11, s3, 12
    s_add_u32 m0, s11, 25088
    s_mov_b32 s10, 0
    buffer_load_dwordx4 v167, s[52:55], s10 offen lds
    s_add_u32 m0, s11, 41472
    s_nop 0
    buffer_load_dwordx4 v167, s[56:59], s10 offen lds
    s_add_u32 m0, s11, 26112
    s_mov_b32 s10, 88064
    buffer_load_dwordx4 v167, s[52:55], s10 offen lds
    s_add_u32 m0, s11, 42496
    s_nop 0
    buffer_load_dwordx4 v167, s[56:59], s10 offen lds
    s_add_u32 m0, s11, 27136
    s_mov_b32 s10, 176128
    buffer_load_dwordx4 v167, s[52:55], s10 offen lds
    s_add_u32 m0, s11, 43520
    s_nop 0
    buffer_load_dwordx4 v167, s[56:59], s10 offen lds
    s_add_u32 m0, s11, 28160
    s_mov_b32 s10, 264192
    buffer_load_dwordx4 v167, s[52:55], s10 offen lds
    s_add_u32 m0, s11, 44544
    s_nop 0
    buffer_load_dwordx4 v167, s[56:59], s10 offen lds
    s_branch L_dend_20
L_ddn_19:
    s_mul_i32 s11, s3, 11264
    s_add_u32 m0, s11, 25088
    s_mov_b32 s10, 0
    buffer_load_dwordx4 v167, s[52:55], s10 offen lds
    s_add_u32 m0, s11, 26112
    s_mov_b32 s10, 32768
    buffer_load_dwordx4 v167, s[52:55], s10 offen lds
    s_add_u32 m0, s11, 27136
    s_mov_b32 s10, 65536
    buffer_load_dwordx4 v167, s[52:55], s10 offen lds
    s_add_u32 m0, s11, 28160
    s_mov_b32 s10, 98304
    buffer_load_dwordx4 v167, s[52:55], s10 offen lds
    s_add_u32 m0, s11, 29184
    s_mov_b32 s10, 131072
    buffer_load_dwordx4 v167, s[52:55], s10 offen lds
    s_add_u32 m0, s11, 30208
    s_mov_b32 s10, 163840
    buffer_load_dwordx4 v167, s[52:55], s10 offen lds
    s_add_u32 m0, s11, 31232
    s_mov_b32 s10, 196608
    buffer_load_dwordx4 v167, s[52:55], s10 offen lds
    s_add_u32 m0, s11, 32256
    s_mov_b32 s10, 229376
    buffer_load_dwordx4 v167, s[52:55], s10 offen lds
    s_add_u32 m0, s11, 33280
    s_mov_b32 s10, 262144
    buffer_load_dwordx4 v167, s[52:55], s10 offen lds
    s_add_u32 m0, s11, 34304
    s_mov_b32 s10, 294912
    buffer_load_dwordx4 v167, s[52:55], s10 offen lds
    s_add_u32 m0, s11, 35328
    s_mov_b32 s10, 327680
    buffer_load_dwordx4 v167, s[52:55], s10 offen lds
L_dend_20:
    v_lshrrev_b32 v7, 2, v3
    v_lshl_add_u32 v7, v2, 3, v7
    v_lshlrev_b32 v7, 5, v7
    v_and_b32 v6, 3, v3
    v_lshl_add_u32 v7, v6, 3, v7
    s_mov_b32 s14, 0
    s_waitcnt vmcnt(0)
L_cnt_23:
    s_nop 0
    v_cmp_gt_u32 vcc, 0x100, v31
    s_nop 4
    s_cbranch_vccz L_cntdone_24
    s_add_u32 s14, s14, 1
    s_cmp_gt_u32 s14, 100000
    s_cbranch_scc1 L_cntdone_24
    s_sleep 32
    v_mov_b32 v31, 0
    global_load_dword v31, v31, s[36:37] sc1
    s_waitcnt vmcnt(0)
    s_branch L_cnt_23
L_cntdone_24:
    s_cmp_eq_u32 s94, 1
    s_cbranch_scc1 L_gu_21
    s_cmp_eq_u32 s94, 2
    s_cbranch_scc1 L_dn_22
    s_endpgm
L_gu_21:
    s_lshl_b32 s10, s3, 12
    v_add_u32 v7, s10, v7
    ds_read_b64_tr_b16 v[96:97], v7 offset:25088
    ds_read_b64_tr_b16 v[98:99], v7 offset:25216
    ds_read_b64_tr_b16 v[100:101], v7 offset:26112
    ds_read_b64_tr_b16 v[102:103], v7 offset:26240
    ds_read_b64_tr_b16 v[104:105], v7 offset:27136
    ds_read_b64_tr_b16 v[106:107], v7 offset:27264
    ds_read_b64_tr_b16 v[108:109], v7 offset:28160
    ds_read_b64_tr_b16 v[110:111], v7 offset:28288
    ds_read_b64_tr_b16 v[112:113], v7 offset:41472
    ds_read_b64_tr_b16 v[114:115], v7 offset:41600
    ds_read_b64_tr_b16 v[116:117], v7 offset:42496
    ds_read_b64_tr_b16 v[118:119], v7 offset:42624
    ds_read_b64_tr_b16 v[120:121], v7 offset:43520
    ds_read_b64_tr_b16 v[122:123], v7 offset:43648
    ds_read_b64_tr_b16 v[124:125], v7 offset:44544
    ds_read_b64_tr_b16 v[126:127], v7 offset:44672
    v_and_b32 v4, 3, v1
    v_lshlrev_b32 v4, 10, v4
    v_mov_b32 v20, 0x3f803f80
    s_barrier
    s_lshl_b32 s10, s3, 8
    v_lshlrev_b32 v5, 10, v2
    v_lshl_add_u32 v5, v3, 4, v5
    v_add_u32 v5, s10, v5
    v_add_u32 v6, 1048576, v5
    s_mov_b32 s14, 0
L_poll_25:
    s_nop 1
    buffer_load_dwordx4 v[32:35], v6, s[48:51], 0 offen sc1
    s_waitcnt vmcnt(0)
    v_max3_u32 v7, v32, v33, v34
    v_max_u32 v7, v7, v35
    v_cmp_eq_u32 vcc, -1, v7
    s_nop 4
    s_cbranch_vccz L_polldone_26
    s_add_u32 s14, s14, 1
    s_cmp_gt_u32 s14, 400000
    s_cbranch_scc1 L_polldone_26
    s_sleep 0
    s_branch L_poll_25
L_polldone_26:
    ds_write_b128 v5, v[32:35] offset:20992
    v_lshlrev_b32 v64, 16, v32
    v_and_b32 v65, 0xffff0000, v32
    v_lshlrev_b32 v66, 16, v33
    v_and_b32 v67, 0xffff0000, v33
    v_lshlrev_b32 v68, 16, v34
    v_and_b32 v69, 0xffff0000, v34
    v_lshlrev_b32 v70, 16, v35
    v_and_b32 v71, 0xffff0000, v35
    v_add_f32 v24, v64, v65
    v_mul_f32 v25, v64, v64
    v_add_f32 v24, v24, v66
    v_add_f32 v24, v24, v67
    v_add_f32 v24, v24, v68
    v_add_f32 v24, v24, v69
    v_add_f32 v24, v24, v70
    v_add_f32 v24, v24, v71
    v_fmac_f32 v25, v65, v65
    v_fmac_f32 v25, v66, v66
    v_fmac_f32 v25, v67, v67
    v_fmac_f32 v25, v68, v68
    v_fmac_f32 v25, v69, v69
    v_fmac_f32 v25, v70, v70
    v_fmac_f32 v25, v71, v71
    v_add_f32 v24, v24, v24 row_ror:8
    s_nop 0
    v_add_f32 v25, v25, v25 row_ror:8
    v_add_f32 v24, v24, v24 row_ror:4
    s_nop 0
    v_add_f32 v25, v25, v25 row_ror:4
    v_add_f32 v24, v24, v24 row_ror:2
    s_nop 0
    v_add_f32 v25, v25, v25 row_ror:2
    v_add_f32 v24, v24, v24 row_ror:1
    s_nop 0
    v_add_f32 v25, v25, v25 row_ror:1
    s_lshl_b32 s10, s3, 5
    v_lshl_add_u32 v6, v2, 3, s10
    ds_write_b64 v6, v[24:25] offset:384
    s_waitcnt lgkmcnt(0)
    s_barrier
    s_lshl_b32 s10, s3, 8
    v_lshl_add_u32 v6, v2, 4, v4
    v_add_u32 v6, s10, v6
    ds_read_b128 v[48:51], v6 offset:20992
    ds_read_b128 v[52:55], v6 offset:21056
    ds_read_b128 v[56:59], v6 offset:21120
    ds_read_b128 v[60:63], v6 offset:21184
    v_cmp_eq_u32 s[10:11], 4, v3
    s_waitcnt lgkmcnt(0)
    s_nop 0
    v_cndmask_b32 v48, v48, v20, s[10:11]
    v_cndmask_b32 v49, v49, v20, s[10:11]
    v_cndmask_b32 v50, v50, v20, s[10:11]
    v_cndmask_b32 v51, v51, v20, s[10:11]
    v_cndmask_b32 v52, v52, v20, s[10:11]
    v_cndmask_b32 v53, v53, v20, s[10:11]
    v_cndmask_b32 v54, v54, v20, s[10:11]
    v_cndmask_b32 v55, v55, v20, s[10:11]
    v_cndmask_b32 v56, v56, v20, s[10:11]
    v_cndmask_b32 v57, v57, v20, s[10:11]
    v_cndmask_b32 v58, v58, v20, s[10:11]
    v_cndmask_b32 v59, v59, v20, s[10:11]
    v_cndmask_b32 v60, v60, v20, s[10:11]
    v_cndmask_b32 v61, v61, v20, s[10:11]
    v_cndmask_b32 v62, v62, v20, s[10:11]
    v_cndmask_b32 v63, v63, v20, s[10:11]
    s_waitcnt lgkmcnt(0)
    v_mfma_f32_16x16x32_bf16 v[8:11], v[48:51], v[96:99], 0
    v_mfma_f32_16x16x32_bf16 v[12:15], v[48:51], v[112:115], 0
    v_mfma_f32_16x16x32_bf16 v[8:11], v[52:55], v[100:103], v[8:11]
    v_mfma_f32_16x16x32_bf16 v[12:15], v[52:55], v[116:119], v[12:15]
    v_mfma_f32_16x16x32_bf16 v[8:11], v[56:59], v[104:107], v[8:11]
    v_mfma_f32_16x16x32_bf16 v[12:15], v[56:59], v[120:123], v[12:15]
    v_mfma_f32_16x16x32_bf16 v[8:11], v[60:63], v[108:111], v[8:11]
    v_mfma_f32_16x16x32_bf16 v[12:15], v[60:63], v[124:127], v[12:15]
    s_lshl_b32 s10, s3, 11
    v_lshl_add_u32 v5, v1, 4, s10
    s_nop 4
    ds_write_b128 v5, v[8:11] offset:12800
    ds_write_b128 v5, v[12:15] offset:13824
    s_cmp_eq_u32 s3, 0
    s_cbranch_scc0 L_g3_28
    v_and_b32 v6, 3, v1
    v_lshlrev_b32 v6, 3, v6
    ds_read_b64 v[64:65], v6 offset:384
    ds_read_b64 v[66:67], v6 offset:416
    ds_read_b64 v[68:69], v6 offset:448
    ds_read_b64 v[70:71], v6 offset:480
    s_waitcnt lgkmcnt(0)
    v_add_f32 v24, v64, v66
    v_add_f32 v25, v68, v70
    v_add_f32 v27, v65, v67
    v_add_f32 v28, v69, v71
    v_add_f32 v24, v24, v25
    v_add_f32 v27, v27, v28
    v_mul_f32 v24, 0x3b000000, v24
    v_mul_f32 v27, 0x3b000000, v27
    v_fma_f32 v27, -v24, v24, v27
    v_max_f32 v27, 0, v27
    v_mov_b32 v26, v24
    v_cvt_pk_bf16_f32 v25, v26, v26
    v_lshlrev_b32 v26, 16, v25
    v_cvt_pk_bf16_f32 v25, v27, v27
    v_lshlrev_b32 v27, 16, v25
    v_add_f32 v27, 0x3727c5ac, v27
    v_cvt_pk_bf16_f32 v25, v27, v27
    v_lshlrev_b32 v27, 16, v25
    v_sqrt_f32 v27, v27
    s_nop 0
    v_cvt_pk_bf16_f32 v25, v27, v27
    v_lshlrev_b32 v27, 16, v25
    v_rcp_f32 v28, v27
L_g3_28:
    s_nop 2
    s_waitcnt lgkmcnt(0)
    s_barrier
    s_cmp_eq_u32 s3, 0
    s_cbranch_scc0 L_guend_27
    v_bfe_u32 v4, v1, 2, 3
    v_and_b32 v5, 3, v1
    v_lshlrev_b32 v6, 5, v4
    v_lshl_add_u32 v7, v5, 2, v6
    v_add_u32 v6, 256, v6
    v_add_u32 v21, 12800, v7
    ds_read2_b32 v[32:33], v21 offset0:0 offset1:4
    v_add_u32 v21, 13824, v7
    ds_read2_b32 v[40:41], v21 offset0:0 offset1:4
    v_add_u32 v21, 12800, v6
    ds_read2_b32 v[48:49], v21 offset0:0 offset1:4
    v_add_u32 v21, 13824, v6
    ds_read2_b32 v[56:57], v21 offset0:0 offset1:4
    v_add_u32 v21, 14848, v7
    ds_read2_b32 v[34:35], v21 offset0:0 offset1:4
    v_add_u32 v21, 15872, v7
    ds_read2_b32 v[42:43], v21 offset0:0 offset1:4
    v_add_u32 v21, 14848, v6
    ds_read2_b32 v[50:51], v21 offset0:0 offset1:4
    v_add_u32 v21, 15872, v6
    ds_read2_b32 v[58:59], v21 offset0:0 offset1:4
    v_add_u32 v21, 16896, v7
    ds_read2_b32 v[36:37], v21 offset0:0 offset1:4
    v_add_u32 v21, 17920, v7
    ds_read2_b32 v[44:45], v21 offset0:0 offset1:4
    v_add_u32 v21, 16896, v6
    ds_read2_b32 v[52:53], v21 offset0:0 offset1:4
    v_add_u32 v21, 17920, v6
    ds_read2_b32 v[60:61], v21 offset0:0 offset1:4
    v_add_u32 v21, 18944, v7
    ds_read2_b32 v[38:39], v21 offset0:0 offset1:4
    v_add_u32 v21, 19968, v7
    ds_read2_b32 v[46:47], v21 offset0:0 offset1:4
    v_add_u32 v21, 18944, v6
    ds_read2_b32 v[54:55], v21 offset0:0 offset1:4
    v_add_u32 v21, 19968, v6
    ds_read2_b32 v[62:63], v21 offset0:0 offset1:4
    v_mul_u32_u24 v5, 2752, v5
    v_lshl_add_u32 v5, v4, 2, v5
    s_lshl_b32 s10, s95, 5
    s_add_u32 s10, s10, 1052672
    v_add_u32 v5, s10, v5
    s_waitcnt lgkmcnt(0)
    v_add_f32 v32, v32, v34
    v_add_f32 v36, v36, v38
    v_add_f32 v33, v33, v35
    v_add_f32 v37, v37, v39
    v_add_f32 v32, v32, v36
    v_add_f32 v33, v33, v37
    v_add_f32 v40, v40, v42
    v_add_f32 v44, v44, v46
    v_add_f32 v41, v41, v43
    v_add_f32 v45, v45, v47
    v_add_f32 v40, v40, v44
    v_add_f32 v41, v41, v45
    v_add_f32 v48, v48, v50
    v_add_f32 v52, v52, v54
    v_add_f32 v49, v49, v51
    v_add_f32 v53, v53, v55
    v_add_f32 v48, v48, v52
    v_add_f32 v49, v49, v53
    v_add_f32 v56, v56, v58
    v_add_f32 v60, v60, v62
    v_add_f32 v57, v57, v59
    v_add_f32 v61, v61, v63
    v_add_f32 v56, v56, v60
    v_add_f32 v57, v57, v61
    v_fma_f32 v8, -v26, v48, v32
    v_fma_f32 v16, -v26, v56, v40
    v_fma_f32 v9, -v26, v49, v33
    v_fma_f32 v17, -v26, v57, v41
    v_mul_f32 v8, v8, v28
    v_mul_f32 v16, v16, v28
    v_mul_f32 v9, v9, v28
    v_mul_f32 v17, v17, v28
    v_cvt_pk_bf16_f32 v24, v8, v9
    v_lshlrev_b32 v8, 16, v24
    v_and_b32 v9, 0xffff0000, v24
    v_cvt_pk_bf16_f32 v24, v16, v17
    v_lshlrev_b32 v16, 16, v24
    v_and_b32 v17, 0xffff0000, v24
    v_mul_f32 v10, s96, v8
    v_sub_f32 v10, 0, v10
    v_exp_f32 v10, v10
    s_nop 0
    v_add_f32 v10, 1.0, v10
    v_rcp_f32 v12, v10
    s_nop 0
    v_mul_f32 v14, v8, v12
    v_fma_f32 v18, -v14, v10, v8
    v_fma_f32 v18, v18, v12, v14
    v_cmp_class_f32 vcc, v18, 3
    s_nop 1
    v_cndmask_b32 v8, v18, v14, vcc
    v_mul_f32 v11, s96, v9
    v_sub_f32 v11, 0, v11
    v_exp_f32 v11, v11
    s_nop 0
    v_add_f32 v11, 1.0, v11
    v_rcp_f32 v13, v11
    s_nop 0
    v_mul_f32 v15, v9, v13
    v_fma_f32 v19, -v15, v11, v9
    v_fma_f32 v19, v19, v13, v15
    v_cmp_class_f32 vcc, v19, 3
    s_nop 1
    v_cndmask_b32 v9, v19, v15, vcc
    v_cvt_pk_bf16_f32 v24, v8, v9
    v_lshlrev_b32 v8, 16, v24
    v_and_b32 v9, 0xffff0000, v24
    v_mul_f32 v8, v8, v16
    v_mul_f32 v9, v9, v17
    v_cvt_pk_bf16_f32 v8, v8, v9
    v_cmp_eq_u32 vcc, -1, v8
    s_nop 1
    v_cndmask_b32 v8, v8, v29, vcc
    s_mov_b32 exec_hi, 0
    buffer_store_dword v8, v5, s[48:51], 0 offen sc1
    s_mov_b64 exec, -1
L_guend_27:
    s_endpgm
L_dn_22:
    s_barrier
    s_mul_i32 s10, s3, 11264
    v_add_u32 v7, s10, v7
    ds_read_b64_tr_b16 v[96:97], v7 offset:25088
    ds_read_b64_tr_b16 v[98:99], v7 offset:25216
    ds_read_b64_tr_b16 v[100:101], v7 offset:26112
    ds_read_b64_tr_b16 v[102:103], v7 offset:26240
    ds_read_b64_tr_b16 v[104:105], v7 offset:27136
    ds_read_b64_tr_b16 v[106:107], v7 offset:27264
    ds_read_b64_tr_b16 v[108:109], v7 offset:28160
    ds_read_b64_tr_b16 v[110:111], v7 offset:28288
    ds_read_b64_tr_b16 v[112:113], v7 offset:29184
    ds_read_b64_tr_b16 v[114:115], v7 offset:29312
    ds_read_b64_tr_b16 v[116:117], v7 offset:30208
    ds_read_b64_tr_b16 v[118:119], v7 offset:30336
    ds_read_b64_tr_b16 v[120:121], v7 offset:31232
    ds_read_b64_tr_b16 v[122:123], v7 offset:31360
    ds_read_b64_tr_b16 v[124:125], v7 offset:32256
    ds_read_b64_tr_b16 v[126:127], v7 offset:32384
    ds_read_b64_tr_b16 v[128:129], v7 offset:33280
    ds_read_b64_tr_b16 v[130:131], v7 offset:33408
    ds_read_b64_tr_b16 v[132:133], v7 offset:34304
    ds_read_b64_tr_b16 v[134:135], v7 offset:34432
    ds_read_b64_tr_b16 v[136:137], v7 offset:35328
    ds_read_b64_tr_b16 v[138:139], v7 offset:35456
    v_add_u32 v4, 0, v1
    v_mul_u32_u24 v5, 1490, v4
    v_lshrrev_b32 v5, 16, v5
    v_mul_u32_u24 v6, 44, v5
    v_sub_u32 v6, v4, v6
    v_mul_u32_u24 v21, 2752, v5
    v_lshl_add_u32 v21, v6, 4, v21
    s_mul_i32 s10, s3, 704
    s_add_u32 s10, s10, 1052672
    v_add_u32 v23, s10, v21
    v_mul_u32_u24 v21, 704, v5
    v_lshl_add_u32 v21, v6, 4, v21
    s_mul_i32 s10, s3, 2816
    v_add_u32 v26, s10, v21
    s_cmp_eq_u32 s3, 3
    s_cselect_b32 s11, 40, 44
    v_cmp_gt_u32 vcc, s11, v6
    v_cmp_gt_u32 s[10:11], 4, v5
    s_and_b64 vcc, vcc, s[10:11]
    s_mul_i32 s10, s3, 704
    s_add_u32 s10, s10, 1052672
    v_mov_b32 v21, s10
    v_cndmask_b32 v23, v21, v23, vcc
    v_mov_b32 v21, 12288
    v_cndmask_b32 v26, v21, v26, vcc
    v_add_u32 v4, 64, v1
    v_mul_u32_u24 v5, 1490, v4
    v_lshrrev_b32 v5, 16, v5
    v_mul_u32_u24 v6, 44, v5
    v_sub_u32 v6, v4, v6
    v_mul_u32_u24 v21, 2752, v5
    v_lshl_add_u32 v21, v6, 4, v21
    s_mul_i32 s10, s3, 704
    s_add_u32 s10, s10, 1052672
    v_add_u32 v24, s10, v21
    v_mul_u32_u24 v21, 704, v5
    v_lshl_add_u32 v21, v6, 4, v21
    s_mul_i32 s10, s3, 2816
    v_add_u32 v27, s10, v21
    s_cmp_eq_u32 s3, 3
    s_cselect_b32 s11, 40, 44
    v_cmp_gt_u32 vcc, s11, v6
    v_cmp_gt_u32 s[10:11], 4, v5
    s_and_b64 vcc, vcc, s[10:11]
    s_mul_i32 s10, s3, 704
    s_add_u32 s10, s10, 1052672
    v_mov_b32 v21, s10
    v_cndmask_b32 v24, v21, v24, vcc
    v_mov_b32 v21, 12288
    v_cndmask_b32 v27, v21, v27, vcc
    v_add_u32 v4, 128, v1
    v_mul_u32_u24 v5, 1490, v4
    v_lshrrev_b32 v5, 16, v5
    v_mul_u32_u24 v6, 44, v5
    v_sub_u32 v6, v4, v6
    v_mul_u32_u24 v21, 2752, v5
    v_lshl_add_u32 v21, v6, 4, v21
    s_mul_i32 s10, s3, 704
    s_add_u32 s10, s10, 1052672
    v_add_u32 v25, s10, v21
    v_mul_u32_u24 v21, 704, v5
    v_lshl_add_u32 v21, v6, 4, v21
    s_mul_i32 s10, s3, 2816
    v_add_u32 v28, s10, v21
    s_cmp_eq_u32 s3, 3
    s_cselect_b32 s11, 40, 44
    v_cmp_gt_u32 vcc, s11, v6
    v_cmp_gt_u32 s[10:11], 4, v5
    s_and_b64 vcc, vcc, s[10:11]
    s_mul_i32 s10, s3, 704
    s_add_u32 s10, s10, 1052672
    v_mov_b32 v21, s10
    v_cndmask_b32 v25, v21, v25, vcc
    v_mov_b32 v21, 12288
    v_cndmask_b32 v28, v21, v28, vcc
    v_and_b32 v4, 7, v1
    v_bfe_u32 v6, v1, 3, 2
    v_lshlrev_b32 v7, 10, v6
    v_lshl_add_u32 v7, v4, 2, v7
    s_lshl_b32 s10, s95, 5
    v_add_u32 v7, s10, v7
    v_add_u32 v16, 1048576, v7
    s_waitcnt lgkmcnt(0)
    s_mov_b32 s14, 0
L_poll_29:
    s_nop 0
    buffer_load_dwordx4 v[76:79], v23, s[48:51], 0 offen sc1
    buffer_load_dwordx4 v[80:83], v24, s[48:51], 0 offen sc1
    buffer_load_dwordx4 v[84:87], v25, s[48:51], 0 offen sc1
    buffer_load_dword v17, v16, s[48:51], 0 offen sc1
    s_waitcnt vmcnt(0)
    v_max3_u32 v18, v76, v77, v78
    v_max3_u32 v18, v18, v79, v80
    v_max3_u32 v18, v18, v81, v82
    v_max3_u32 v18, v18, v83, v84
    v_max3_u32 v18, v18, v85, v86
    v_max3_u32 v18, v18, v87, v17
    v_cmp_eq_u32 vcc, -1, v18
    s_nop 4
    s_cbranch_vccz L_polldone_30
    s_add_u32 s14, s14, 1
    s_cmp_gt_u32 s14, 400000
    s_cbranch_scc1 L_polldone_30
    s_sleep 0
    s_branch L_poll_29
L_polldone_30:
    ds_write_b128 v26, v[76:79] offset:4608
    ds_write_b128 v27, v[80:83] offset:4608
    ds_write_b128 v28, v[84:87] offset:4608
    v_and_b32 v5, 3, v1
    v_mul_u32_u24 v5, 704, v5
    v_lshl_add_u32 v5, v2, 4, v5
    s_mul_i32 s10, s3, 2816
    v_add_u32 v5, s10, v5
    s_waitcnt lgkmcnt(0)
    ds_read_b128 v[32:35], v5 offset:4608
    ds_read_b128 v[36:39], v5 offset:4672
    ds_read_b128 v[40:43], v5 offset:4736
    ds_read_b128 v[44:47], v5 offset:4800
    ds_read_b128 v[48:51], v5 offset:4864
    ds_read_b128 v[52:55], v5 offset:4928
    ds_read_b128 v[56:59], v5 offset:4992
    ds_read_b128 v[60:63], v5 offset:5056
    ds_read_b128 v[64:67], v5 offset:5120
    ds_read_b128 v[68:71], v5 offset:5184
    ds_read_b128 v[72:75], v5 offset:5248
    s_cmp_eq_u32 s3, 3
    s_waitcnt lgkmcnt(0)
    s_cbranch_scc1 L_w3_31
    v_mfma_f32_16x16x32_bf16 v[8:11], v[72:75], v[136:139], 0
    s_branch L_dj_32
L_w3_31:
    s_nop 6
    v_mov_b32 v8, 0
    v_mov_b32 v9, 0
    v_mov_b32 v10, 0
    v_mov_b32 v11, 0
L_dj_32:
    s_nop 2
    v_mfma_f32_16x16x32_bf16 v[8:11], v[32:35], v[96:99], v[8:11]
    v_mfma_f32_16x16x32_bf16 v[8:11], v[36:39], v[100:103], v[8:11]
    v_mfma_f32_16x16x32_bf16 v[8:11], v[40:43], v[104:107], v[8:11]
    v_mfma_f32_16x16x32_bf16 v[8:11], v[44:47], v[108:111], v[8:11]
    v_mfma_f32_16x16x32_bf16 v[8:11], v[48:51], v[112:115], v[8:11]
    v_mfma_f32_16x16x32_bf16 v[8:11], v[52:55], v[116:119], v[8:11]
    v_mfma_f32_16x16x32_bf16 v[8:11], v[56:59], v[120:123], v[8:11]
    v_mfma_f32_16x16x32_bf16 v[8:11], v[60:63], v[124:127], v[8:11]
    v_mfma_f32_16x16x32_bf16 v[8:11], v[64:67], v[128:131], v[8:11]
    v_mfma_f32_16x16x32_bf16 v[8:11], v[68:71], v[132:135], v[8:11]
    s_lshl_b32 s10, s3, 10
    v_lshl_add_u32 v5, v1, 4, s10
    s_nop 5
    ds_write_b128 v5, v[8:11] offset:20992
    s_waitcnt lgkmcnt(0)
    s_barrier
    s_cmp_eq_u32 s3, 0
    s_cbranch_scc0 L_dnend_33
    v_lshlrev_b32 v5, 5, v4
    v_lshl_add_u32 v5, v6, 2, v5
    v_add_u32 v19, 20992, v5
    ds_read2_b32 v[8:9], v19 offset0:0 offset1:4
    v_add_u32 v19, 22016, v5
    ds_read2_b32 v[10:11], v19 offset0:0 offset1:4
    v_add_u32 v19, 23040, v5
    ds_read2_b32 v[12:13], v19 offset0:0 offset1:4
    v_add_u32 v19, 24064, v5
    ds_read2_b32 v[14:15], v19 offset0:0 offset1:4
    s_waitcnt lgkmcnt(0)
    v_add_f32 v8, v8, v10
    v_add_f32 v12, v12, v14
    v_add_f32 v9, v9, v11
    v_add_f32 v13, v13, v15
    v_add_f32 v8, v8, v12
    v_add_f32 v9, v9, v13
    v_cvt_pk_bf16_f32 v24, v8, v9
    v_lshlrev_b32 v8, 16, v24
    v_and_b32 v9, 0xffff0000, v24
    v_lshlrev_b32 v10, 16, v17
    v_and_b32 v11, 0xffff0000, v17
    v_add_f32 v8, v8, v10
    v_add_f32 v9, v9, v11
    v_cvt_pk_bf16_f32 v8, v8, v9
    s_mov_b32 exec_hi, 0
    global_store_dword v7, v8, s[34:35]
    s_mov_b64 exec, -1
L_dnend_33:
L_END:
    s_endpgm
.section .rodata,"a"
.p2align 6
.amdhsa_kernel sequential_preLN__sliding_block_cached__swiglu_ffn__decode_kernel
  .amdhsa_next_free_vgpr 168
  .amdhsa_next_free_sgpr 102
  .amdhsa_accum_offset 168
  .amdhsa_group_segment_fixed_size 0
  .amdhsa_kernarg_size 96
  .amdhsa_user_sgpr_count 2
  .amdhsa_user_sgpr_kernarg_segment_ptr 1
  .amdhsa_system_sgpr_workgroup_id_x 1
.end_amdhsa_kernel
```
